```python
import torch

def _softmax(x, axis=-1):
    return torch.softmax(x, dim=axis)
def _gelu(x):
    return torch.nn.functional.gelu(x, approximate="tanh")
def _silu(x):
    return torch.nn.functional.silu(x)
def _sigmoid(x):
    return torch.sigmoid(x)
def _layernorm(x, axis=-1, eps=1e-5):
    m = x.mean(dim=axis, keepdim=True)
    v = x.var(dim=axis, keepdim=True, unbiased=False)
    return (x - m) / torch.sqrt(v + eps)
def _scatter_add(tgt, idx, src, axis=0):
    return tgt.clone().index_add_(axis, idx, src)
def _segment_sum(src, seg, n):
    out = torch.zeros((n,) + src.shape[1:], dtype=src.dtype)
    return out.index_add_(0, seg, src)
def _pad(x, pw):
    flat = tuple(v for pair in reversed(pw) for v in pair)
    return torch.nn.functional.pad(x, flat)

kernel_name = 'gated_mix__ssm_conv_s4d__ssm_conv_s4d__prompt'

def setup_inputs():

    _w = (lambda a: (lambda t: t.to(torch.bfloat16) if t.is_floating_point() else t)(torch.as_tensor(a)))
    def _A_setup():
        Bsz, L, D, N = 1, 2048, 512, 128
        return {
            "u": _w((lambda *s: torch.randn(*s, dtype=torch.bfloat16) * 0.05)(Bsz, L, D)),
            "log_A_real": _w((lambda *s: torch.randn(*s, dtype=torch.bfloat16) * 6.4)(D, N) * 0.5),
            "A_imag": _w((lambda *s: torch.randn(*s, dtype=torch.bfloat16) * 0.05)(D, N) * 3.14),
            "C_real": _w((lambda *s: torch.randn(*s, dtype=torch.bfloat16) * 0.05)(D, N) / N ** 0.5),
            "C_imag": _w((lambda *s: torch.randn(*s, dtype=torch.bfloat16) * 0.05)(D, N) / N ** 0.5),
            "log_dt": _w((lambda *s: torch.randn(*s, dtype=torch.bfloat16) * 0.05)(D) * 0.5 - 4.0),
            "D_skip": _w((lambda *s: torch.randn(*s, dtype=torch.bfloat16) * 0.05)(D)),
        }
    _A_in = _A_setup()

    def _B_setup():
        Bsz, L, D, N = 1, 2048, 512, 128
        return {
            "u": _w((lambda *s: torch.randn(*s, dtype=torch.bfloat16) * 0.05)(Bsz, L, D)),
            "log_A_real": _w((lambda *s: torch.randn(*s, dtype=torch.bfloat16) * 6.4)(D, N) * 0.5),
            "A_imag": _w((lambda *s: torch.randn(*s, dtype=torch.bfloat16) * 0.05)(D, N) * 3.14),
            "C_real": _w((lambda *s: torch.randn(*s, dtype=torch.bfloat16) * 0.05)(D, N) / N ** 0.5),
            "C_imag": _w((lambda *s: torch.randn(*s, dtype=torch.bfloat16) * 0.05)(D, N) / N ** 0.5),
            "log_dt": _w((lambda *s: torch.randn(*s, dtype=torch.bfloat16) * 0.05)(D) * 0.5 - 4.0),
            "D_skip": _w((lambda *s: torch.randn(*s, dtype=torch.bfloat16) * 0.05)(D)),
        }
    _B_in = _B_setup()

    return {
        "A_u": _A_in["u"],
        "A_log_A_real": _A_in["log_A_real"],
        "A_A_imag": _A_in["A_imag"],
        "A_C_real": _A_in["C_real"],
        "A_C_imag": _A_in["C_imag"],
        "A_log_dt": _A_in["log_dt"],
        "A_D_skip": _A_in["D_skip"],
        "B_u": _B_in["u"],
        "B_log_A_real": _B_in["log_A_real"],
        "B_A_imag": _B_in["A_imag"],
        "B_C_real": _B_in["C_real"],
        "B_C_imag": _B_in["C_imag"],
        "B_log_dt": _B_in["log_dt"],
        "B_D_skip": _B_in["D_skip"],
        "gate_w": _w((lambda *s: torch.randn(*s, dtype=torch.bfloat16) * 0.05)(512) * 16.0),
    }

def reference(A_u, A_log_A_real, A_A_imag, A_C_real, A_C_imag, A_log_dt, A_D_skip, B_u, B_log_A_real, B_A_imag, B_C_real, B_C_imag, B_log_dt, B_D_skip, gate_w):
    def _A_ref(u, log_A_real, A_imag, C_real, C_imag, log_dt, D_skip):
        L = u.shape[1]
        dt = torch.exp(log_dt)
        A = -torch.exp(log_A_real) + 1j * A_imag
        C = (C_real + 1j * C_imag) * dt[:, None]
        pos = (lambda x, dt: x.to(dt))(torch.arange(L), log_dt.dtype)
        P = torch.exp((A * dt[:, None])[:, :, None] * pos[None, None, :])
        K = 2.0 * torch.einsum("dn,dnl->dl", C, P).real
        L2 = 2 * L
        u_t = (lambda x, *d: x.permute(*d))(u, 0, 2, 1)
        Kf = (lambda x, *a, **k: torch.fft.rfft(x.float(), *a, **k))(K, L2)
        Uf = (lambda x, *a, **k: torch.fft.rfft(x.float(), *a, **k))(u_t, L2)
        y = (lambda x, *a, **k: torch.fft.irfft(x, *a, **k).to(torch.bfloat16))(Uf * Kf[None, :, :], L2)[:, :, :L]
        y = (lambda x, *d: x.permute(*d))(y, 0, 2, 1)
        return y + u * D_skip[None, None, :]

    def _B_ref(u, log_A_real, A_imag, C_real, C_imag, log_dt, D_skip):
        L = u.shape[1]
        dt = torch.exp(log_dt)
        A = -torch.exp(log_A_real) + 1j * A_imag
        C = (C_real + 1j * C_imag) * dt[:, None]
        pos = (lambda x, dt: x.to(dt))(torch.arange(L), log_dt.dtype)
        P = torch.exp((A * dt[:, None])[:, :, None] * pos[None, None, :])
        K = 2.0 * torch.einsum("dn,dnl->dl", C, P).real
        L2 = 2 * L
        u_t = (lambda x, *d: x.permute(*d))(u, 0, 2, 1)
        Kf = (lambda x, *a, **k: torch.fft.rfft(x.float(), *a, **k))(K, L2)
        Uf = (lambda x, *a, **k: torch.fft.rfft(x.float(), *a, **k))(u_t, L2)
        y = (lambda x, *a, **k: torch.fft.irfft(x, *a, **k).to(torch.bfloat16))(Uf * Kf[None, :, :], L2)[:, :, :L]
        y = (lambda x, *d: x.permute(*d))(y, 0, 2, 1)
        return y + u * D_skip[None, None, :]

    x = A_u
    g = _sigmoid((x * gate_w).sum(-1, keepdims=True))
    a = _A_ref(x, A_log_A_real, A_A_imag, A_C_real, A_C_imag, A_log_dt, A_D_skip)
    b = _B_ref(x, B_log_A_real, B_A_imag, B_C_real, B_C_imag, B_log_dt, B_D_skip)
    return g * a + (1 - g) * b
```

```asm
; @launch grid=(256,1,1) block=(512,1,1) lds=160096
.amdgcn_target "amdgcn-amd-amdhsa--gfx950"
.text
.globl gated_mix__ssm_conv_s4d__ssm_conv_s4d__prompt_kernel
.p2align 8
.type gated_mix__ssm_conv_s4d__ssm_conv_s4d__prompt_kernel,@function
gated_mix__ssm_conv_s4d__ssm_conv_s4d__prompt_kernel:
    s_cmp_ge_u32 s2, 0x100
    s_cbranch_scc1 L_end
    s_getpc_b64 s[6:7]
L_pc:
    v_lshrrev_b32 v1, 6, v0
    s_andn2_b32 s4, s2, 7
    v_add_lshl_u32 v2, v1, s4, 7
    v_readfirstlane_b32 s3, v1
    v_min_u32 v2, L_fin-L_pc-4, v2
    global_load_dword v255, v2, s[6:7]
    s_bfe_u32 s4, s3, 0x10001
    s_mul_i32 s4, s4, 56
    s_add_u32 s52, s0, s4
    s_addc_u32 s53, s1, 0
    s_load_dwordx8 s[8:15], s[52:53], 8
    s_load_dwordx4 s[16:19], s[52:53], 40
    s_load_dwordx2 s[56:57], s[0:1], 0
    s_load_dwordx4 s[60:63], s[0:1], 112
    s_load_dwordx4 s[40:43], s[0:1], 128
    s_memrealtime s[50:51]
    v_and_b32 v0, 63, v0
    v_mov_b32 v28, 0
    v_mov_b32 v29, 0
    v_mov_b32 v30, 0
    v_mov_b32_e64 v31, 0
    v_mov_b32 v186, 159872
    s_and_b32 s48, s2, 7
    s_lshr_b32 s5, s2, 3
    s_lshl_b32 s44, s48, 5
    s_add_u32 s44, s44, s5
    s_and_b32 s45, s3, 3
    s_and_b32 s46, s3, 1
    s_lshl_b32 s4, s44, 1
    s_add_u32 s4, s4, s46
    s_lshl_b32 s4, s4, 8
    v_lshl_add_u32 v5, v0, 2, s4
    s_lshl_b32 s47, s44, 2
    s_mul_i32 s22, s3, 15504
    s_mov_b32 m0, s22
    v_lshlrev_b32 v184, 4, v0
    s_lshl_b32 s4, s46, 1
    s_add_u32 s4, s4, s47
    v_mov_b32 v7, s4
    v_mov_b32 v33, 0
    v_mov_b32 v61, 0
    v_lshrrev_b32 v6, 3, v0
    v_and_b32 v34, 0x70, v184
    v_lshl_add_u32 v6, v6, 10, v34
    v_and_b32 v34, 32, v0
    v_xor_b32 v6, v34, v6
    s_lshl_b32 s49, s48, 7
    s_lshl_b32 s4, s5, 16
    s_add_u32 s4, s4, s49
    s_lshl_b32 s23, s45, 14
    s_add_u32 s4, s4, s23
    v_add_u32 v176, s4, v6
    v_xor_b32 v185, 64, v176
    s_lshl_b32 s4, s5, 14
    s_lshl_b32 s38, s45, 19
    s_add_u32 s38, s38, s4
    s_add_u32 s38, s38, s49
    s_lshr_b32 s4, s5, 3
    s_lshl_b32 s4, s4, 19
    s_add_u32 s39, s4, s49
    s_and_b32 s4, s5, 7
    s_lshl_b32 s4, s4, 2
    s_add_u32 s4, s4, s45
    s_lshr_b32 s4, s4, 1
    s_lshl_b32 s4, s4, 10
    s_add_u32 s39, s39, s4
    s_lshl_b32 s4, s46, 6
    s_add_u32 s39, s39, s4
    s_getreg_b32 s54, hwreg(HW_REG_XCC_ID, 0, 4)
    s_add_u32 s6, s6, L_tab-L_pc
    s_addc_u32 s7, s7, 0
    s_mov_b32 s58, 0x200000
    s_mov_b32 s59, 0x20000
    s_mov_b32 s21, 7168
    s_waitcnt lgkmcnt(0)
    global_load_dword v1, v5, s[8:9]
    global_load_short_d16_hi v33, v7, s[16:17]
    global_load_dword v2, v5, s[10:11]
    s_cmp_ge_u32 s3, 4
    s_cbranch_scc0 L_par
    buffer_load_dwordx4 v[204:207], v176, s[56:59], 0 offen
    buffer_load_dwordx4 v[208:211], v185, s[56:59], s21 offen offset:1024
    s_lshl_b32 s4, s48, 5
    v_mov_b32 v188, s4
    s_or_b32 s4, s5, s45
    s_cbranch_scc1 L_io2
    s_or_b32 s50, s50, 1
    v_mov_b32 v190, s50
    s_mov_b64 exec, 1
    global_store_dword v188, v190, s[40:41] sc1
    s_mov_b64 exec, -1
L_io2:
    global_load_dword v3, v5, s[12:13]
    global_load_dword v4, v5, s[14:15]
    s_branch L_io
L_par:
    s_setprio 2
    s_add_u32 s6, s6, 2048
    s_addc_u32 s7, s7, 0
    global_load_dword v3, v5, s[12:13]
    global_load_dword v4, v5, s[14:15]
    global_load_short_d16_hi v61, v7, s[18:19]
    s_mov_b32 s24, 0x3fb8aa3b
    s_mov_b32 s28, 0
    s_mov_b32 s29, 0x80000000
    v_mov_b32 v32, 0x3c00
    s_mul_i32 s23, s3, 6656
    s_add_u32 s23, s23, 133248
    v_mov_b32 v63, s23
    ds_write_addtid_b32 v32 offset:0
    s_mul_i32 s30, s46, 4608
    s_mul_i32 s31, s46, 15504
    s_lshl_b32 s4, s3, 2
    s_add_u32 s4, s4, 159936
    v_mov_b32 v8, s4
    v_min_u32 v9, 0x70, v184
    v_add_u32_e64 v9, s4, v9
    ds_write_b32 v9, v28
    s_lshl_b32 s4, s3, 3
    s_add_u32 s4, s4, 160064
    v_mov_b32 v10, s4
    ds_write_b64 v10, v[28:29]
    v_subrev_u32_e64 v10, 48, v8
    ds_write2_b32 v10, v28, v28 offset0:0 offset1:4
    v_min_u32_e64 v10, 59, v0
    s_add_u32 s4, s30, 124032
    v_lshl_add_u32 v10, v10, 3, s4
    ds_write_b64 v10, v[28:29]
    v_and_b32_e64 v36, 15, v0
    v_lshl_add_u32 v253, v36, 10, s38
    s_waitcnt vmcnt(4)
    v_mul_f32 v33, s24, v33
    v_exp_f32 v33, v33
    s_nop 0
    v_cvt_pk_bf16_f32 v33, v33, v33
    v_lshlrev_b32 v33, 16, v33
    v_lshlrev_b32 v42, 16, v1
    s_add_u32 s8, s47, s45
    s_lshl_b32 s8, s8, 11
    v_add_u32 v185, s8, v184
    v_subrev_u32 v9, 16, v8
    v_mul_f32 v42, s24, v42
    v_exp_f32 v42, v42
    s_waitcnt vmcnt(3)
    v_lshlrev_b32 v43, 16, v2
    global_load_dword v254, v253, s[62:63]
    v_cvt_pk_bf16_f32 v42, v42, v42
    v_mul_f32 v43, v33, v43
    v_lshlrev_b32 v42, 16, v42
    v_mul_f32_e64 v43, 0.15915494, v43
    v_mul_f32_e64 v42, -v33, v42
    v_fract_f32 v40, v43
    v_mul_f32 v42, s24, v42
    v_cos_f32 v36, v40
    v_exp_f32 v46, v42
    v_sin_f32 v37, v40
    s_nop 0
    v_pk_mul_f32 v[36:37], v[36:37], v[46:47] op_sel_hi:[1,0]
    v_cvt_pk_f16_f32 v50, v36, v37
    v_pk_mul_f32 v[40:41], v[36:37], v[36:37] op_sel_hi:[0,1]
    v_pk_fma_f32 v[36:37], v[36:37], v[36:37], v[40:41] op_sel:[1,1,0] op_sel_hi:[1,0,1] neg_lo:[1,0,0]
    v_cvt_pk_f16_f32 v51, v36, v37
    v_pk_mul_f32 v[40:41], v[36:37], v[36:37] op_sel_hi:[0,1]
    v_pk_fma_f32 v[36:37], v[36:37], v[36:37], v[40:41] op_sel:[1,1,0] op_sel_hi:[1,0,1] neg_lo:[1,0,0]
    v_cvt_pk_f16_f32 v52, v36, v37
    v_pk_mul_f32 v[40:41], v[36:37], v[36:37] op_sel_hi:[0,1]
    v_pk_fma_f32 v[36:37], v[36:37], v[36:37], v[40:41] op_sel:[1,1,0] op_sel_hi:[1,0,1] neg_lo:[1,0,0]
    v_cvt_pk_f16_f32 v53, v36, v37
    ds_write_addtid_b32 v53 offset:272
    v_pk_mul_f32 v[40:41], v[36:37], v[36:37] op_sel_hi:[0,1]
    v_pk_fma_f32 v[36:37], v[36:37], v[36:37], v[40:41] op_sel:[1,1,0] op_sel_hi:[1,0,1] neg_lo:[1,0,0]
    v_cvt_pk_f16_f32 v54, v36, v37
    ds_write_addtid_b32 v54 offset:544
    v_pk_mul_f32 v[40:41], v[36:37], v[36:37] op_sel_hi:[0,1]
    v_pk_fma_f32 v[36:37], v[36:37], v[36:37], v[40:41] op_sel:[1,1,0] op_sel_hi:[1,0,1] neg_lo:[1,0,0]
    v_cvt_pk_f16_f32 v55, v36, v37
    ds_write_addtid_b32 v55 offset:1088
    v_pk_mul_f32 v[40:41], v[36:37], v[36:37] op_sel_hi:[0,1]
    v_pk_fma_f32 v[36:37], v[36:37], v[36:37], v[40:41] op_sel:[1,1,0] op_sel_hi:[1,0,1] neg_lo:[1,0,0]
    v_cvt_pk_f16_f32 v56, v36, v37
    ds_write_addtid_b32 v56 offset:2176
    v_pk_mul_f32 v[40:41], v[36:37], v[36:37] op_sel_hi:[0,1]
    v_pk_fma_f32 v[36:37], v[36:37], v[36:37], v[40:41] op_sel:[1,1,0] op_sel_hi:[1,0,1] neg_lo:[1,0,0]
    v_cvt_pk_f16_f32 v57, v36, v37
    ds_write_addtid_b32 v57 offset:4352
    v_pk_mul_f32 v[40:41], v[36:37], v[36:37] op_sel_hi:[0,1]
    v_pk_fma_f32 v[36:37], v[36:37], v[36:37], v[40:41] op_sel:[1,1,0] op_sel_hi:[1,0,1] neg_lo:[1,0,0]
    v_cvt_pk_f16_f32 v58, v36, v37
    v_pk_mul_f32 v[40:41], v[36:37], v[36:37] op_sel_hi:[0,1]
    v_pk_fma_f32 v[36:37], v[36:37], v[36:37], v[40:41] op_sel:[1,1,0] op_sel_hi:[1,0,1] neg_lo:[1,0,0]
    v_cvt_pk_f16_f32 v59, v36, v37
    v_pk_mul_f32 v[40:41], v[36:37], v[36:37] op_sel_hi:[0,1]
    v_pk_fma_f32 v[36:37], v[36:37], v[36:37], v[40:41] op_sel:[1,1,0] op_sel_hi:[1,0,1] neg_lo:[1,0,0]
    v_cvt_pk_f16_f32 v60, v36, v37
    s_setprio 0
    s_nop 0
    v_pk_mul_f16 v147, v53, v54 op_sel_hi:[0,1]
    v_pk_fma_f16 v147, v53, v54, v147 op_sel:[1,1,0] op_sel_hi:[1,0,1] neg_lo:[1,0,0]
    ds_write_addtid_b32 v147 offset:816
    v_pk_mul_f16 v149, v53, v55 op_sel_hi:[0,1]
    v_pk_fma_f16 v149, v53, v55, v149 op_sel:[1,1,0] op_sel_hi:[1,0,1] neg_lo:[1,0,0]
    ds_write_addtid_b32 v149 offset:1360
    v_pk_mul_f16 v150, v54, v55 op_sel_hi:[0,1]
    v_pk_fma_f16 v150, v54, v55, v150 op_sel:[1,1,0] op_sel_hi:[1,0,1] neg_lo:[1,0,0]
    ds_write_addtid_b32 v150 offset:1632
    v_pk_mul_f16 v151, v147, v55 op_sel_hi:[0,1]
    v_pk_fma_f16 v151, v147, v55, v151 op_sel:[1,1,0] op_sel_hi:[1,0,1] neg_lo:[1,0,0]
    ds_write_addtid_b32 v151 offset:1904
    v_pk_mul_f16 v153, v53, v56 op_sel_hi:[0,1]
    global_load_dwordx4 v[240:243], v184, s[6:7] offset:-2048
    v_pk_fma_f16 v153, v53, v56, v153 op_sel:[1,1,0] op_sel_hi:[1,0,1] neg_lo:[1,0,0]
    ds_write_addtid_b32 v153 offset:2448
    v_pk_mul_f16 v154, v54, v56 op_sel_hi:[0,1]
    v_pk_fma_f16 v154, v54, v56, v154 op_sel:[1,1,0] op_sel_hi:[1,0,1] neg_lo:[1,0,0]
    ds_write_addtid_b32 v154 offset:2720
    v_pk_mul_f16 v155, v147, v56 op_sel_hi:[0,1]
    v_pk_fma_f16 v155, v147, v56, v155 op_sel:[1,1,0] op_sel_hi:[1,0,1] neg_lo:[1,0,0]
    ds_write_addtid_b32 v155 offset:2992
    v_pk_mul_f16 v156, v55, v56 op_sel_hi:[0,1]
    s_waitcnt vmcnt(4)
    v_and_b32 v34, 0x7fff7fff, v3
    v_pk_fma_f16 v156, v55, v56, v156 op_sel:[1,1,0] op_sel_hi:[1,0,1] neg_lo:[1,0,0]
    ds_write_addtid_b32 v156 offset:3264
    v_pk_mul_f16 v157, v149, v56 op_sel_hi:[0,1]
    s_waitcnt vmcnt(3)
    v_and_b32 v35, 0x7fff7fff, v4
    v_pk_fma_f16 v157, v149, v56, v157 op_sel:[1,1,0] op_sel_hi:[1,0,1] neg_lo:[1,0,0]
    ds_write_addtid_b32 v157 offset:3536
    v_pk_mul_f16 v158, v150, v56 op_sel_hi:[0,1]
    v_pk_max_u16 v34, v34, v35
    v_pk_fma_f16 v158, v150, v56, v158 op_sel:[1,1,0] op_sel_hi:[1,0,1] neg_lo:[1,0,0]
    ds_write_addtid_b32 v158 offset:3808
    v_pk_mul_f16 v159, v151, v56 op_sel_hi:[0,1]
    v_lshrrev_b32_e64 v35, 16, v34
    v_pk_fma_f16 v159, v151, v56, v159 op_sel:[1,1,0] op_sel_hi:[1,0,1] neg_lo:[1,0,0]
    ds_write_addtid_b32 v159 offset:4080
    v_pk_mul_f16 v163, v53, v57 op_sel_hi:[0,1]
    buffer_load_dwordx4 v[192:195], v185, s[56:59], 0 offen
    buffer_load_dwordx4 v[196:199], v185, s[56:59], 0 offen offset:1024
    global_load_dwordx4 v[200:203], v184, s[60:61]
    v_and_b32 v34, 0xffff, v34
    v_pk_fma_f16 v163, v53, v57, v163 op_sel:[1,1,0] op_sel_hi:[1,0,1] neg_lo:[1,0,0]
    ds_write_addtid_b32 v163 offset:4624
    v_pk_mul_f16 v160, v54, v57 op_sel_hi:[0,1]
    v_max_u32_e64 v34, v34, v35
    v_pk_fma_f16 v160, v54, v57, v160 op_sel:[1,1,0] op_sel_hi:[1,0,1] neg_lo:[1,0,0]
    ds_write_addtid_b32 v160 offset:4896
    v_pk_mul_f16 v161, v147, v57 op_sel_hi:[0,1]
    v_max_u32_dpp v34, v34, v34 row_shr:1 row_mask:0xf bank_mask:0xf
    v_pk_fma_f16 v161, v147, v57, v161 op_sel:[1,1,0] op_sel_hi:[1,0,1] neg_lo:[1,0,0]
    ds_write_addtid_b32 v161 offset:5168
    v_pk_mul_f16 v162, v55, v57 op_sel_hi:[0,1]
    v_max_u32_dpp v34, v34, v34 row_shr:2 row_mask:0xf bank_mask:0xf
    v_pk_fma_f16 v162, v55, v57, v162 op_sel:[1,1,0] op_sel_hi:[1,0,1] neg_lo:[1,0,0]
    ds_write_addtid_b32 v162 offset:5440
    v_pk_mul_f16 v163, v149, v57 op_sel_hi:[0,1]
    v_max_u32_dpp v34, v34, v34 row_shr:4 row_mask:0xf bank_mask:0xf
    v_pk_fma_f16 v163, v149, v57, v163 op_sel:[1,1,0] op_sel_hi:[1,0,1] neg_lo:[1,0,0]
    s_waitcnt vmcnt(3)
    v_add_u32 v240, s22, v240
    v_add_u32 v241, s22, v241
    v_add_u32 v242, s23, v242
    ds_write_b128 v242, v[28:31]
    ds_write_addtid_b32 v163 offset:5712
    v_pk_mul_f16 v160, v150, v57 op_sel_hi:[0,1]
    v_max_u32_dpp v34, v34, v34 row_shr:8 row_mask:0xf bank_mask:0xf
    v_pk_fma_f16 v160, v150, v57, v160 op_sel:[1,1,0] op_sel_hi:[1,0,1] neg_lo:[1,0,0]
    ds_write_addtid_b32 v160 offset:5984
    v_pk_mul_f16 v161, v151, v57 op_sel_hi:[0,1]
    v_max_u32_dpp v34, v34, v34 row_bcast:15 row_mask:0xa bank_mask:0xf
    v_pk_fma_f16 v161, v151, v57, v161 op_sel:[1,1,0] op_sel_hi:[1,0,1] neg_lo:[1,0,0]
    ds_write_addtid_b32 v161 offset:6256
    v_pk_mul_f16 v162, v56, v57 op_sel_hi:[0,1]
    v_max_u32_dpp v34, v34, v34 row_bcast:31 row_mask:0xc bank_mask:0xf
    v_pk_fma_f16 v162, v56, v57, v162 op_sel:[1,1,0] op_sel_hi:[1,0,1] neg_lo:[1,0,0]
    ds_write_addtid_b32 v162 offset:6528
    v_pk_mul_f16 v163, v153, v57 op_sel_hi:[0,1]
    v_readlane_b32 s34, v34, 63
    v_pk_fma_f16 v163, v153, v57, v163 op_sel:[1,1,0] op_sel_hi:[1,0,1] neg_lo:[1,0,0]
    ds_write_addtid_b32 v163 offset:6800
    v_pk_mul_f16 v160, v154, v57 op_sel_hi:[0,1]
    s_lshr_b32 s34, s34, 7
    s_max_u32 s34, s34, 11
    s_sub_u32 s36, 264, s34
    s_lshl_b32 s36, s36, 23
    s_mov_b32 s37, s36
    s_sub_u32 s35, s34, 9
    s_lshl_b32 s35, s35, 23
    v_pk_fma_f16 v160, v154, v57, v160 op_sel:[1,1,0] op_sel_hi:[1,0,1] neg_lo:[1,0,0]
    ds_write_addtid_b32 v160 offset:7072
    v_pk_mul_f16 v161, v155, v57 op_sel_hi:[0,1]
    v_mul_f32_e64 v62, s35, v33
    v_pk_fma_f16 v161, v155, v57, v161 op_sel:[1,1,0] op_sel_hi:[1,0,1] neg_lo:[1,0,0]
    ds_write_addtid_b32 v161 offset:7344
    v_pk_mul_f16 v162, v156, v57 op_sel_hi:[0,1]
    v_pk_fma_f16 v162, v156, v57, v162 op_sel:[1,1,0] op_sel_hi:[1,0,1] neg_lo:[1,0,0]
    ds_write_addtid_b32 v162 offset:7616
    v_pk_mul_f16 v163, v157, v57 op_sel_hi:[0,1]
    v_pk_fma_f16 v163, v157, v57, v163 op_sel:[1,1,0] op_sel_hi:[1,0,1] neg_lo:[1,0,0]
    ds_write_addtid_b32 v163 offset:7888
    v_pk_mul_f16 v160, v158, v57 op_sel_hi:[0,1]
    v_pk_fma_f16 v160, v158, v57, v160 op_sel:[1,1,0] op_sel_hi:[1,0,1] neg_lo:[1,0,0]
    ds_write_addtid_b32 v160 offset:8160
    v_pk_mul_f16 v161, v159, v57 op_sel_hi:[0,1]
    v_pk_fma_f16 v161, v159, v57, v161 op_sel:[1,1,0] op_sel_hi:[1,0,1] neg_lo:[1,0,0]
    ds_write_addtid_b32 v161 offset:8432
    v_lshlrev_b32 v40, 16, v3
    v_lshlrev_b32 v41, 16, v4
    v_pk_mul_f32 v[40:41], v[40:41], s[36:37]
    v_cvt_pk_f16_f32 v164, v40, -v41
    ds_write_addtid_b32 v164 offset:9792
    ds_read_b128 v[96:99], v240 offset:0
    v_pk_mul_f16 v162, v164, v50 op_sel_hi:[0,1] neg_hi:[0,1]
    v_pk_fma_f16 v162, v164, v50, v162 op_sel:[1,1,0] op_sel_hi:[1,0,1]
    ds_write_addtid_b32 v162 offset:10064
    v_pk_mul_f16 v165, v164, v51 op_sel_hi:[0,1] neg_hi:[0,1]
    v_pk_fma_f16 v165, v164, v51, v165 op_sel:[1,1,0] op_sel_hi:[1,0,1]
    ds_write_addtid_b32 v165 offset:10336
    ds_read_b128 v[100:103], v240 offset:32
    v_pk_mul_f16 v160, v165, v50 op_sel_hi:[0,1] neg_hi:[0,1]
    v_pk_fma_f16 v160, v165, v50, v160 op_sel:[1,1,0] op_sel_hi:[1,0,1]
    ds_write_addtid_b32 v160 offset:10608
    v_pk_mul_f16 v166, v164, v52 op_sel_hi:[0,1] neg_hi:[0,1]
    v_pk_fma_f16 v166, v164, v52, v166 op_sel:[1,1,0] op_sel_hi:[1,0,1]
    ds_write_addtid_b32 v166 offset:8704
    ds_read_b128 v[104:107], v240 offset:64
    v_pk_mul_f16 v162, v166, v50 op_sel_hi:[0,1] neg_hi:[0,1]
    v_pk_fma_f16 v162, v166, v50, v162 op_sel:[1,1,0] op_sel_hi:[1,0,1]
    ds_write_addtid_b32 v162 offset:8976
    v_pk_mul_f16 v167, v166, v51 op_sel_hi:[0,1] neg_hi:[0,1]
    v_pk_fma_f16 v167, v166, v51, v167 op_sel:[1,1,0] op_sel_hi:[1,0,1]
    ds_write_addtid_b32 v167 offset:9248
    ds_read_b128 v[108:111], v240 offset:96
    v_pk_mul_f16 v160, v167, v50 op_sel_hi:[0,1] neg_hi:[0,1]
    v_pk_fma_f16 v160, v167, v50, v160 op_sel:[1,1,0] op_sel_hi:[1,0,1]
    ds_write_addtid_b32 v160 offset:9520
    v_pk_mul_f16 v168, v164, v53 op_sel_hi:[0,1] neg_hi:[0,1]
    v_pk_fma_f16 v168, v164, v53, v168 op_sel:[1,1,0] op_sel_hi:[1,0,1]
    ds_write_addtid_b32 v168 offset:10880
    ds_read_b128 v[112:115], v240 offset:128
    v_pk_mul_f16 v162, v168, v50 op_sel_hi:[0,1] neg_hi:[0,1]
    v_pk_fma_f16 v162, v168, v50, v162 op_sel:[1,1,0] op_sel_hi:[1,0,1]
    ds_write_addtid_b32 v162 offset:11152
    v_pk_mul_f16 v169, v168, v51 op_sel_hi:[0,1] neg_hi:[0,1]
    s_waitcnt vmcnt(0)
    s_nop 0
    v_dot2_f32_bf16 v236, v192, v200, 0
    v_dot2_f32_bf16 v237, v196, v200, 0
    v_pk_fma_f16 v169, v168, v51, v169 op_sel:[1,1,0] op_sel_hi:[1,0,1]
    ds_read_b128 v[116:119], v240 offset:160
    v_dot2_f32_bf16 v236, v193, v201, v236
    v_dot2_f32_bf16 v237, v197, v201, v237
    ds_write_addtid_b32 v169 offset:11424
    v_dot2_f32_bf16 v236, v194, v202, v236
    v_dot2_f32_bf16 v237, v198, v202, v237
    v_pk_mul_f16 v160, v164, v58 op_sel_hi:[0,1] neg_hi:[0,1]
    v_dot2_f32_bf16 v236, v195, v203, v236
    v_dot2_f32_bf16 v237, v199, v203, v237
    v_pk_fma_f16 v160, v164, v58, v160 op_sel:[1,1,0] op_sel_hi:[1,0,1]
    ds_read_b128 v[120:123], v240 offset:192
    s_nop 0
    v_permlane32_swap_b32 v236, v237
    ds_write_addtid_b32 v160 offset:14144
    v_add_f32_e64 v236, v236, v237
    v_pk_mul_f16 v161, v165, v58 op_sel_hi:[0,1] neg_hi:[0,1]
    s_nop 0
    s_nop 0
    v_add_f32_dpp v236, v236, v236 row_shr:1 row_mask:0xf bank_mask:0xf bound_ctrl:1
    v_pk_fma_f16 v161, v165, v58, v161 op_sel:[1,1,0] op_sel_hi:[1,0,1]
    ds_read_b128 v[124:127], v240 offset:224
    v_add_f32_dpp v236, v236, v236 row_shr:2 row_mask:0xf bank_mask:0xf bound_ctrl:1
    ds_write_addtid_b32 v161 offset:11968
    s_nop 0
    v_add_f32_dpp v236, v236, v236 row_shr:4 row_mask:0xf bank_mask:0xf bound_ctrl:1
    v_pk_mul_f16 v162, v166, v58 op_sel_hi:[0,1] neg_hi:[0,1]
    s_nop 0
    v_add_f32_dpp v236, v236, v236 row_shr:8 row_mask:0xf bank_mask:0xf bound_ctrl:1
    v_pk_fma_f16 v162, v166, v58, v162 op_sel:[1,1,0] op_sel_hi:[1,0,1]
    global_load_dwordx4 v[12:15], v184, s[6:7] offset:0
    global_load_dwordx4 v[16:19], v184, s[6:7] offset:1024
    global_load_dwordx4 v[20:23], v184, s[6:7] offset:2048
    global_load_dwordx4 v[4:7], v184, s[6:7] offset:-1024
    v_add_f32_dpp v236, v236, v236 row_bcast:15 row_mask:0xa bank_mask:0xf
    ds_write_addtid_b32 v162 offset:12240
    v_cvt_pk_bf16_f32 v236, v236, v236
    v_lshlrev_b32_e64 v236, 16, v236
    v_mul_f32 v236, 0xbfb8aa3b, v236
    v_exp_f32_e64 v236, v236
    v_pk_mul_f16 v163, v167, v58 op_sel_hi:[0,1] neg_hi:[0,1]
    v_add_f32 v236, 1.0, v236
    v_rcp_f32 v236, v236
    v_pk_fma_f16 v163, v167, v58, v163 op_sel:[1,1,0] op_sel_hi:[1,0,1]
    v_cvt_pk_bf16_f32 v236, v236, v236
    ds_write_addtid_b32 v163 offset:12512
    v_readlane_b32 s8, v236, 31
    v_readlane_b32 s9, v236, 63
    s_pack_ll_b32_b16 s8, s8, s9
    v_mov_b32 v214, s8
    v_pk_mul_f16 v170, v168, v58 op_sel_hi:[0,1] neg_hi:[0,1]
    ds_write_b32 v9, v214
    v_pk_fma_f16 v170, v168, v58, v170 op_sel:[1,1,0] op_sel_hi:[1,0,1]
    ds_write_addtid_b32 v170 offset:12784
    v_pk_mul_f16 v161, v169, v58 op_sel_hi:[0,1] neg_hi:[0,1]
    v_pk_fma_f16 v161, v169, v58, v161 op_sel:[1,1,0] op_sel_hi:[1,0,1]
    ds_write_addtid_b32 v161 offset:13056
    v_pk_mul_f16 v171, v166, v59 op_sel_hi:[0,1] neg_hi:[0,1]
    v_pk_fma_f16 v171, v166, v59, v171 op_sel:[1,1,0] op_sel_hi:[1,0,1]
    ds_write_addtid_b32 v171 offset:13600
    v_pk_mul_f16 v172, v168, v59 op_sel_hi:[0,1] neg_hi:[0,1]
    v_pk_fma_f16 v172, v168, v59, v172 op_sel:[1,1,0] op_sel_hi:[1,0,1]
    ds_write_addtid_b32 v172 offset:13328
    v_pk_mul_f16 v160, v171, v58 op_sel_hi:[0,1] neg_hi:[0,1]
    v_pk_fma_f16 v160, v171, v58, v160 op_sel:[1,1,0] op_sel_hi:[1,0,1]
    ds_write_addtid_b32 v160 offset:14688
    v_pk_mul_f16 v173, v172, v58 op_sel_hi:[0,1] neg_hi:[0,1]
    v_pk_fma_f16 v173, v172, v58, v173 op_sel:[1,1,0] op_sel_hi:[1,0,1]
    ds_write_addtid_b32 v173 offset:14416
    v_pk_mul_f16 v162, v168, v60 op_sel_hi:[0,1] neg_hi:[0,1]
    v_pk_fma_f16 v162, v168, v60, v162 op_sel:[1,1,0] op_sel_hi:[1,0,1]
    ds_write_addtid_b32 v162 offset:13872
    v_pk_mul_f16 v163, v170, v60 op_sel_hi:[0,1] neg_hi:[0,1]
    v_pk_fma_f16 v163, v170, v60, v163 op_sel:[1,1,0] op_sel_hi:[1,0,1]
    ds_write_addtid_b32 v163 offset:14960
    v_pk_mul_f16 v160, v172, v60 op_sel_hi:[0,1] neg_hi:[0,1]
    v_pk_fma_f16 v160, v172, v60, v160 op_sel:[1,1,0] op_sel_hi:[1,0,1]
    ds_write_addtid_b32 v160 offset:11696
    v_pk_mul_f16 v161, v173, v60 op_sel_hi:[0,1] neg_hi:[0,1]
    v_pk_fma_f16 v161, v173, v60, v161 op_sel:[1,1,0] op_sel_hi:[1,0,1]
    ds_write_addtid_b32 v161 offset:15232
    ds_read_b128 v[64:67], v241 offset:0
    ds_read_b128 v[68:71], v241 offset:32
    ds_read_b128 v[72:75], v241 offset:64
    ds_read_b128 v[76:79], v241 offset:96
    ds_read_b128 v[80:83], v241 offset:128
    ds_read_b128 v[84:87], v241 offset:160
    ds_read_b128 v[88:91], v241 offset:192
    ds_read_b128 v[92:95], v241 offset:224
    s_waitcnt lgkmcnt(7)
    v_mfma_f32_32x32x16_f16 v[128:143], v[64:67], v[96:99], 0
    v_add_u32 v243, s23, v243
    s_waitcnt vmcnt(3)
    v_add_u32 v12, s23, v12
    s_waitcnt lgkmcnt(6)
    v_mfma_f32_32x32x16_f16 v[128:143], v[68:71], v[100:103], v[128:143]
    v_add_u32 v13, s23, v13
    v_add_u32 v14, s23, v14
    s_waitcnt lgkmcnt(5)
    v_mfma_f32_32x32x16_f16 v[128:143], v[72:75], v[104:107], v[128:143]
    v_add_u32 v15, s30, v15
    s_waitcnt vmcnt(2)
    v_add_u32 v16, s22, v16
    s_waitcnt lgkmcnt(4)
    v_mfma_f32_32x32x16_f16 v[128:143], v[76:79], v[108:111], v[128:143]
    v_add_u32 v17, s31, v17
    v_add_u32 v18, s31, v18
    s_waitcnt lgkmcnt(3)
    v_mfma_f32_32x32x16_f16 v[128:143], v[80:83], v[112:115], v[128:143]
    v_add_u32 v19, s31, v19
    s_waitcnt lgkmcnt(2)
    v_mfma_f32_32x32x16_f16 v[128:143], v[84:87], v[116:119], v[128:143]
    s_waitcnt vmcnt(0)
    v_add_u32 v7, s31, v7
    s_waitcnt lgkmcnt(1)
    v_mfma_f32_32x32x16_f16 v[128:143], v[88:91], v[120:123], v[128:143]
    v_add_u32 v5, s22, v184
    s_waitcnt lgkmcnt(0)
    v_mfma_f32_32x32x16_f16 v[128:143], v[92:95], v[124:127], v[128:143]
    s_lshl_b32 s4, s3, 3
    s_add_u32 s4, s4, 160064
    v_mov_b32 v6, s4
    s_nop 8
    s_nop 0
    ds_write_b128 v5, v[136:139]
    ds_write_b128 v5, v[140:143] offset:1024
    v_pk_mul_f32 v[128:129], v[128:129], v[62:63] op_sel_hi:[1,0]
    v_pk_mul_f32 v[130:131], v[130:131], v[62:63] op_sel_hi:[1,0]
    v_pk_mul_f32 v[132:133], v[132:133], v[62:63] op_sel_hi:[1,0]
    v_pk_mul_f32 v[134:135], v[134:135], v[62:63] op_sel_hi:[1,0]
    s_waitcnt lgkmcnt(0)
    s_barrier
    s_setprio 2
    ds_read_b128 v[152:155], v5 offset:62016
    ds_read_b128 v[156:159], v5 offset:63040
    ds_read_b128 v[248:251], v186
    s_waitcnt lgkmcnt(2)
    v_pk_fma_f32 v[128:129], v[152:153], v[62:63], v[128:129] op_sel_hi:[1,0,1]
    v_pk_fma_f32 v[130:131], v[154:155], v[62:63], v[130:131] op_sel_hi:[1,0,1]
    s_waitcnt lgkmcnt(1)
    v_pk_fma_f32 v[132:133], v[156:157], v[62:63], v[132:133] op_sel_hi:[1,0,1]
    v_pk_fma_f32 v[134:135], v[158:159], v[62:63], v[134:135] op_sel_hi:[1,0,1]
    s_mov_b64 exec, 1
    v_add_f32 v128, v61, v128
    s_mov_b64 exec, s[28:29]
    v_mov_b32 v133, v132
    s_mov_b64 exec, -1
    v_cvt_pk_bf16_f32 v144, v131, v130
    v_cvt_pk_bf16_f32 v145, v129, v128
    ds_write_b64 v243, v[144:145] offset:4552
    v_cvt_pk_bf16_f32 v146, v132, v131
    v_cvt_pk_bf16_f32 v147, v130, v129
    ds_write_b64 v243, v[146:147] offset:512
    v_cvt_pk_bf16_f32 v148, v133, v132
    v_cvt_pk_bf16_f32 v149, v131, v130
    ds_write_b64 v243, v[148:149] offset:1856
    v_cvt_pk_bf16_f32 v150, v134, v133
    v_cvt_pk_bf16_f32 v151, v132, v131
    ds_write_b64 v243, v[150:151] offset:3200
    v_cvt_pk_bf16_f32 v160, v128, 0
    s_mov_b64 exec, 1
    ds_write_b32 v63, v160 offset:1080
    ds_write_b32 v63, v145 offset:2424
    ds_write_b32 v63, v147 offset:3768
    ds_write_b32 v63, v160 offset:3772
    s_mov_b64 exec, -1
L_uchk:
    s_waitcnt lgkmcnt(8)
    v_min3_u32 v249, v249, v250, v251
    v_min_u32 v249, v248, v249
    v_cmp_eq_u32 vcc, 0, v249
    s_cbranch_vccz L_uok
    ds_read_b128 v[248:251], v186 offset:0
    s_waitcnt lgkmcnt(0)
    s_branch L_uchk
L_uok:
    s_setprio 0
    s_nop 0
    ds_read_b64 v[92:93], v12 offset:576
    ds_read_b64 v[94:95], v12 offset:584
    ds_read_b128 v[28:31], v15 offset:0
    ds_read_b128 v[168:171], v15 offset:512
    ds_read_b64 v[88:89], v12 offset:640
    ds_read_b64 v[90:91], v12 offset:648
    ds_read_b128 v[32:35], v15 offset:64
    ds_read_b128 v[172:175], v15 offset:576
    ds_read_b64 v[84:85], v12 offset:704
    ds_read_b64 v[86:87], v12 offset:712
    ds_read_b128 v[36:39], v15 offset:128
    s_waitcnt lgkmcnt(8)
    v_mfma_f32_16x16x32_bf16 v[192:195], v[92:95], v[28:31], 0
    ds_read_b128 v[176:179], v15 offset:640
    s_waitcnt lgkmcnt(8)
    v_mfma_f32_16x16x32_bf16 v[196:199], v[92:95], v[168:171], 0
    ds_read_b64 v[80:81], v12 offset:768
    ds_read_b64 v[82:83], v12 offset:776
    ds_read_b128 v[40:43], v15 offset:192
    s_waitcnt lgkmcnt(8)
    v_mfma_f32_16x16x32_bf16 v[192:195], v[88:91], v[32:35], v[192:195]
    ds_read_b128 v[180:183], v15 offset:704
    s_waitcnt lgkmcnt(8)
    v_mfma_f32_16x16x32_bf16 v[196:199], v[88:91], v[172:175], v[196:199]
    ds_read_b64 v[76:77], v12 offset:832
    ds_read_b64 v[78:79], v12 offset:840
    ds_read_b128 v[44:47], v15 offset:256
    s_waitcnt lgkmcnt(8)
    v_mfma_f32_16x16x32_bf16 v[192:195], v[84:87], v[36:39], v[192:195]
    ds_read_b128 v[224:227], v15 offset:768
    s_waitcnt lgkmcnt(8)
    v_mfma_f32_16x16x32_bf16 v[196:199], v[84:87], v[176:179], v[196:199]
    ds_read_b64 v[72:73], v12 offset:896
    ds_read_b64 v[74:75], v12 offset:904
    ds_read_b128 v[48:51], v15 offset:320
    s_waitcnt lgkmcnt(8)
    v_mfma_f32_16x16x32_bf16 v[192:195], v[80:83], v[40:43], v[192:195]
    ds_read_b128 v[228:231], v15 offset:832
    s_waitcnt lgkmcnt(8)
    v_mfma_f32_16x16x32_bf16 v[196:199], v[80:83], v[180:183], v[196:199]
    ds_read_b64 v[68:69], v12 offset:960
    ds_read_b64 v[70:71], v12 offset:968
    ds_read_b64 v[10:11], v6
    ds_read_b128 v[52:55], v15 offset:384
    s_waitcnt lgkmcnt(9)
    v_mfma_f32_16x16x32_bf16 v[192:195], v[76:79], v[44:47], v[192:195]
    ds_read_b128 v[232:235], v15 offset:896
    s_waitcnt lgkmcnt(9)
    v_mfma_f32_16x16x32_bf16 v[196:199], v[76:79], v[224:227], v[196:199]
    ds_read_b64 v[64:65], v12 offset:1024
    ds_read_b64 v[66:67], v12 offset:1032
    ds_read_b128 v[56:59], v15 offset:448
    s_waitcnt lgkmcnt(9)
    v_mfma_f32_16x16x32_bf16 v[192:195], v[72:75], v[48:51], v[192:195]
L_pchk:
    s_waitcnt lgkmcnt(5)
    v_cmp_eq_u32 vcc, 0, v11
    s_cbranch_vccz L_pok
    ds_read_b64 v[10:11], v6
    s_waitcnt lgkmcnt(0)
    s_branch L_pchk
L_pok:
    ds_read_b128 v[236:239], v15 offset:960
    v_mfma_f32_16x16x32_bf16 v[196:199], v[72:75], v[228:231], v[196:199]
    ds_read_b64 v[124:125], v12 offset:64
    ds_read_b64 v[126:127], v12 offset:72
    s_waitcnt lgkmcnt(7)
    v_mfma_f32_16x16x32_bf16 v[192:195], v[68:71], v[52:55], v[192:195]
    ds_read_b64 v[120:121], v12 offset:128
    s_waitcnt lgkmcnt(7)
    v_mfma_f32_16x16x32_bf16 v[196:199], v[68:71], v[232:235], v[196:199]
    ds_read_b64 v[122:123], v12 offset:136
    s_waitcnt lgkmcnt(5)
    v_mfma_f32_16x16x32_bf16 v[192:195], v[64:67], v[56:59], v[192:195]
    ds_read_b64 v[116:117], v12 offset:192
    s_waitcnt lgkmcnt(5)
    v_mfma_f32_16x16x32_bf16 v[196:199], v[64:67], v[236:239], v[196:199]
    ds_read_b64 v[118:119], v12 offset:200
    s_waitcnt lgkmcnt(4)
    v_mfma_f32_16x16x32_bf16 v[196:199], v[124:127], v[28:31], v[196:199]
    ds_read_b64 v[112:113], v12 offset:256
    v_mfma_f32_16x16x32_bf16 v[200:203], v[124:127], v[168:171], 0
    ds_read_b64 v[114:115], v12 offset:264
    s_waitcnt lgkmcnt(4)
    v_mfma_f32_16x16x32_bf16 v[196:199], v[120:123], v[32:35], v[196:199]
    ds_read_b64 v[108:109], v12 offset:320
    v_mfma_f32_16x16x32_bf16 v[200:203], v[120:123], v[172:175], v[200:203]
    ds_read_b64 v[110:111], v12 offset:328
    s_waitcnt lgkmcnt(4)
    v_mfma_f32_16x16x32_bf16 v[196:199], v[116:119], v[36:39], v[196:199]
    ds_write_b64 v16, v[192:193] offset:0
    v_mfma_f32_16x16x32_bf16 v[200:203], v[116:119], v[176:179], v[200:203]
    ds_read_b64 v[104:105], v12 offset:384
    ds_read_b64 v[106:107], v12 offset:392
    s_waitcnt lgkmcnt(5)
    v_mfma_f32_16x16x32_bf16 v[196:199], v[112:115], v[40:43], v[196:199]
    ds_write_b64 v16, v[194:195] offset:640
    v_mfma_f32_16x16x32_bf16 v[200:203], v[112:115], v[180:183], v[200:203]
    ds_read_b64 v[100:101], v12 offset:448
    ds_read_b64 v[102:103], v12 offset:456
    s_waitcnt lgkmcnt(6)
    v_mfma_f32_16x16x32_bf16 v[196:199], v[108:111], v[44:47], v[196:199]
    ds_write_b32 v8, v8 offset:0
    v_mfma_f32_16x16x32_bf16 v[200:203], v[108:111], v[224:227], v[200:203]
    ds_read_b64 v[96:97], v12 offset:512
    ds_read_b64 v[98:99], v12 offset:520
    s_waitcnt lgkmcnt(6)
    v_mfma_f32_16x16x32_bf16 v[196:199], v[104:107], v[48:51], v[196:199]
    ds_read_b64 v[24:25], v12 offset:0
    v_mfma_f32_16x16x32_bf16 v[200:203], v[104:107], v[228:231], v[200:203]
    ds_read_b64 v[26:27], v12 offset:8
    s_waitcnt lgkmcnt(5)
    v_mfma_f32_16x16x32_bf16 v[196:199], v[100:103], v[52:55], v[196:199]
    ds_read_b128 v[28:31], v15 offset:1024
    v_mfma_f32_16x16x32_bf16 v[200:203], v[100:103], v[232:235], v[200:203]
    v_and_b32 v20, v10, v20
    v_and_b32 v21, v10, v21
    s_waitcnt lgkmcnt(3)
    v_mfma_f32_16x16x32_bf16 v[196:199], v[96:99], v[56:59], v[196:199]
    ds_read_b128 v[32:35], v15 offset:1088
    v_mfma_f32_16x16x32_bf16 v[200:203], v[96:99], v[236:239], v[200:203]
    v_and_b32 v22, v10, v22
    v_and_b32 v23, v10, v23
    s_waitcnt lgkmcnt(2)
    v_mfma_f32_16x16x32_bf16 v[200:203], v[24:27], v[56:59], v[200:203]
    ds_read_b128 v[36:39], v15 offset:1152
    v_mfma_f32_16x16x32_bf16 v[204:207], v[24:27], v[236:239], 0
    ds_write_b64 v16, v[196:197] offset:1184
    s_waitcnt lgkmcnt(3)
    v_mfma_f32_16x16x32_bf16 v[200:203], v[92:95], v[28:31], v[200:203]
    ds_read_b128 v[40:43], v15 offset:1216
    v_mfma_f32_16x16x32_bf16 v[204:207], v[124:127], v[28:31], v[204:207]
    ds_write_b64 v16, v[198:199] offset:1824
    v_mfma_f32_16x16x32_bf16 v[208:211], v[20:23], v[56:59], 0
    ds_read_b128 v[44:47], v15 offset:1280
    v_mfma_f32_16x16x32_bf16 v[212:215], v[20:23], v[236:239], 0
    ds_write_b32 v8, v8 offset:16
    s_waitcnt lgkmcnt(6)
    v_mfma_f32_16x16x32_bf16 v[200:203], v[88:91], v[32:35], v[200:203]
    ds_read_b128 v[48:51], v15 offset:1344
    v_mfma_f32_16x16x32_bf16 v[204:207], v[120:123], v[32:35], v[204:207]
    ds_read_b128 v[52:55], v15 offset:1408
    s_waitcnt lgkmcnt(7)
    v_mfma_f32_16x16x32_bf16 v[200:203], v[84:87], v[36:39], v[200:203]
    ds_read_b128 v[56:59], v15 offset:1472
    v_mfma_f32_16x16x32_bf16 v[204:207], v[116:119], v[36:39], v[204:207]
    ds_read_b128 v[168:171], v15 offset:1536
    s_waitcnt lgkmcnt(7)
    v_mfma_f32_16x16x32_bf16 v[200:203], v[80:83], v[40:43], v[200:203]
    ds_read_b128 v[172:175], v15 offset:1600
    v_mfma_f32_16x16x32_bf16 v[204:207], v[112:115], v[40:43], v[204:207]
    ds_read_b128 v[176:179], v15 offset:1664
    s_waitcnt lgkmcnt(7)
    v_mfma_f32_16x16x32_bf16 v[200:203], v[76:79], v[44:47], v[200:203]
    ds_read_b128 v[180:183], v15 offset:1728
    v_mfma_f32_16x16x32_bf16 v[204:207], v[108:111], v[44:47], v[204:207]
    ds_read_b128 v[224:227], v15 offset:1792
    s_waitcnt lgkmcnt(7)
    v_mfma_f32_16x16x32_bf16 v[200:203], v[72:75], v[48:51], v[200:203]
    ds_read_b128 v[228:231], v15 offset:1856
    v_mfma_f32_16x16x32_bf16 v[204:207], v[104:107], v[48:51], v[204:207]
    ds_read_b128 v[232:235], v15 offset:1920
    s_waitcnt lgkmcnt(8)
    v_mfma_f32_16x16x32_bf16 v[200:203], v[68:71], v[52:55], v[200:203]
    ds_read_b128 v[236:239], v15 offset:1984
    v_mfma_f32_16x16x32_bf16 v[204:207], v[100:103], v[52:55], v[204:207]
    ds_read_b128 v[248:251], v186 offset:32
    s_waitcnt lgkmcnt(9)
    v_mfma_f32_16x16x32_bf16 v[200:203], v[64:67], v[56:59], v[200:203]
    ds_read_b128 v[28:31], v15 offset:2048
    v_mfma_f32_16x16x32_bf16 v[204:207], v[96:99], v[56:59], v[204:207]
    ds_read_b128 v[32:35], v15 offset:2112
    v_mfma_f32_16x16x32_bf16 v[208:211], v[24:27], v[56:59], v[208:211]
    ds_read_b64 v[160:161], v13 offset:256
    v_mfma_f32_16x16x32_bf16 v[216:219], v[20:23], v[56:59], 0
L_wchk:
    s_waitcnt lgkmcnt(3)
    v_min3_u32 v249, v249, v250, v251
    v_min_u32 v249, v248, v249
    v_cmp_eq_u32 vcc, 0, v249
    s_cbranch_vccz L_wok
    ds_read_b128 v[248:251], v186 offset:32
    s_waitcnt lgkmcnt(0)
    s_branch L_wchk
L_wok:
    v_mfma_f32_16x16x32_bf16 v[204:207], v[92:95], v[168:171], v[204:207]
    ds_read_b64 v[162:163], v13 offset:264
    v_mfma_f32_16x16x32_bf16 v[208:211], v[124:127], v[168:171], v[208:211]
    ds_read_b64_tr_b16 v[244:245], v17 offset:0
    v_mfma_f32_16x16x32_bf16 v[204:207], v[88:91], v[172:175], v[204:207]
    ds_read_b64_tr_b16 v[246:247], v18 offset:0
    v_mfma_f32_16x16x32_bf16 v[208:211], v[120:123], v[172:175], v[208:211]
    ds_read_b64 v[152:153], v13 offset:128
    v_mfma_f32_16x16x32_bf16 v[204:207], v[84:87], v[176:179], v[204:207]
    ds_read_b64 v[154:155], v13 offset:136
    v_mfma_f32_16x16x32_bf16 v[208:211], v[116:119], v[176:179], v[208:211]
    ds_read_b64 v[144:145], v13 offset:0
    v_mfma_f32_16x16x32_bf16 v[204:207], v[80:83], v[180:183], v[204:207]
    ds_read_b64 v[146:147], v13 offset:8
    v_mfma_f32_16x16x32_bf16 v[208:211], v[112:115], v[180:183], v[208:211]
    ds_read_b128 v[36:39], v15 offset:2176
    v_mfma_f32_16x16x32_bf16 v[204:207], v[76:79], v[224:227], v[204:207]
    ds_read_b64 v[164:165], v13 offset:320
    v_mfma_f32_16x16x32_bf16 v[208:211], v[108:111], v[224:227], v[208:211]
    ds_read_b64 v[166:167], v13 offset:328
    v_mfma_f32_16x16x32_bf16 v[204:207], v[72:75], v[228:231], v[204:207]
    ds_read_b64_tr_b16 v[252:253], v17 offset:272
    v_mfma_f32_16x16x32_bf16 v[208:211], v[104:107], v[228:231], v[208:211]
    ds_read_b64_tr_b16 v[254:255], v18 offset:272
    v_mfma_f32_16x16x32_bf16 v[204:207], v[68:71], v[232:235], v[204:207]
    ds_read_b64 v[156:157], v13 offset:192
    v_mfma_f32_16x16x32_bf16 v[208:211], v[100:103], v[232:235], v[208:211]
    ds_read_b64 v[158:159], v13 offset:200
    v_mfma_f32_16x16x32_bf16 v[204:207], v[64:67], v[236:239], v[204:207]
    ds_read_b64 v[148:149], v13 offset:64
    v_mfma_f32_16x16x32_bf16 v[208:211], v[96:99], v[236:239], v[208:211]
    ds_read_b64 v[150:151], v13 offset:72
    v_mfma_f32_16x16x32_bf16 v[212:215], v[24:27], v[236:239], v[212:215]
    ds_read_b128 v[40:43], v15 offset:2240
    v_mfma_f32_16x16x32_bf16 v[220:223], v[20:23], v[236:239], 0
    ds_read_b64_tr_b16 v[188:189], v17 offset:544
    s_waitcnt lgkmcnt(15)
    v_mfma_f32_16x16x32_bf16 v[208:211], v[92:95], v[28:31], v[208:211]
    ds_read_b64_tr_b16 v[190:191], v18 offset:544
    v_mfma_f32_16x16x32_bf16 v[212:215], v[124:127], v[28:31], v[212:215]
    ds_read_b128 v[44:47], v15 offset:2304
    v_mfma_f32_16x16x32_bf16 v[208:211], v[88:91], v[32:35], v[208:211]
    ds_read_b128 v[48:51], v15 offset:2368
    v_mfma_f32_16x16x32_bf16 v[212:215], v[120:123], v[32:35], v[212:215]
    ds_read_b64 v[140:141], v14 offset:192
    v_mfma_f32_16x16x32_bf16 v[200:203], v[244:247], v[160:163], v[200:203]
    ds_read_b64 v[142:143], v14 offset:200
    s_waitcnt lgkmcnt(15)
    v_mfma_f32_16x16x32_bf16 v[204:207], v[244:247], v[152:155], v[204:207]
    ds_read_b64 v[136:137], v14 offset:128
    v_mfma_f32_16x16x32_bf16 v[208:211], v[244:247], v[144:147], v[208:211]
    ds_read_b64_tr_b16 v[244:245], v17 offset:816
    v_mfma_f32_16x16x32_bf16 v[208:211], v[84:87], v[36:39], v[208:211]
    ds_read_b64_tr_b16 v[246:247], v18 offset:816
    v_mfma_f32_16x16x32_bf16 v[212:215], v[116:119], v[36:39], v[212:215]
    ds_read_b64 v[138:139], v14 offset:136
    s_waitcnt lgkmcnt(15)
    v_mfma_f32_16x16x32_bf16 v[200:203], v[252:255], v[164:167], v[200:203]
    ds_read_b64 v[132:133], v14 offset:64
    s_waitcnt lgkmcnt(14)
    v_mfma_f32_16x16x32_bf16 v[204:207], v[252:255], v[156:159], v[204:207]
    ds_read_b64 v[134:135], v14 offset:72
    s_waitcnt lgkmcnt(13)
    v_mfma_f32_16x16x32_bf16 v[208:211], v[252:255], v[148:151], v[208:211]
    s_nop 1
    ds_write_b64 v16, v[200:201] offset:2368
    s_waitcnt lgkmcnt(13)
    v_mfma_f32_16x16x32_bf16 v[208:211], v[80:83], v[40:43], v[208:211]
    ds_read_b64_tr_b16 v[252:253], v19 offset:0
    v_mfma_f32_16x16x32_bf16 v[212:215], v[112:115], v[40:43], v[212:215]
    ds_write_b64 v16, v[202:203] offset:3008
    s_waitcnt lgkmcnt(13)
    v_mfma_f32_16x16x32_bf16 v[204:207], v[188:191], v[160:163], v[204:207]
    ds_read_b64_tr_b16 v[254:255], v7 offset:0
    v_mfma_f32_16x16x32_bf16 v[208:211], v[188:191], v[152:155], v[208:211]
    ds_write_b32 v8, v8 offset:32
    v_mfma_f32_16x16x32_bf16 v[212:215], v[188:191], v[144:147], v[212:215]
    ds_read_b64 v[128:129], v14 offset:0
    s_waitcnt lgkmcnt(15)
    v_mfma_f32_16x16x32_bf16 v[208:211], v[76:79], v[44:47], v[208:211]
    ds_read_b64 v[130:131], v14 offset:8
    v_mfma_f32_16x16x32_bf16 v[212:215], v[108:111], v[44:47], v[212:215]
    ds_read_b128 v[52:55], v15 offset:2432
    s_waitcnt lgkmcnt(11)
    v_mfma_f32_16x16x32_bf16 v[204:207], v[244:247], v[164:167], v[204:207]
    ds_read_b128 v[56:59], v15 offset:2496
    v_mfma_f32_16x16x32_bf16 v[208:211], v[244:247], v[156:159], v[208:211]
    ds_read_b128 v[168:171], v15 offset:2560
    v_mfma_f32_16x16x32_bf16 v[212:215], v[244:247], v[148:151], v[212:215]
    s_nop 3
    ds_write_b64 v16, v[204:205] offset:3552
    v_mfma_f32_16x16x32_bf16 v[208:211], v[72:75], v[48:51], v[208:211]
    ds_read_b128 v[172:175], v15 offset:2624
    v_mfma_f32_16x16x32_bf16 v[212:215], v[104:107], v[48:51], v[212:215]
    ds_write_b64 v16, v[206:207] offset:4192
    s_waitcnt lgkmcnt(9)
    v_mfma_f32_16x16x32_bf16 v[208:211], v[252:255], v[140:143], v[208:211]
    ds_read_b64_tr_b16 v[188:189], v17 offset:1088
    v_mfma_f32_16x16x32_bf16 v[212:215], v[252:255], v[136:139], v[212:215]
    ds_write_b32 v8, v8 offset:48
    v_mfma_f32_16x16x32_bf16 v[216:219], v[252:255], v[132:135], v[216:219]
    ds_read_b64_tr_b16 v[190:191], v18 offset:1088
    s_waitcnt lgkmcnt(9)
    v_mfma_f32_16x16x32_bf16 v[220:223], v[252:255], v[128:131], v[220:223]
    ds_read_b128 v[176:179], v15 offset:2688
    s_waitcnt lgkmcnt(9)
    v_mfma_f32_16x16x32_bf16 v[208:211], v[68:71], v[52:55], v[208:211]
    ds_read_b64_tr_b16 v[244:245], v17 offset:1360
    v_mfma_f32_16x16x32_bf16 v[212:215], v[100:103], v[52:55], v[212:215]
    ds_read_b64_tr_b16 v[246:247], v18 offset:1360
    s_waitcnt lgkmcnt(10)
    v_mfma_f32_16x16x32_bf16 v[208:211], v[64:67], v[56:59], v[208:211]
    ds_read_b128 v[180:183], v15 offset:2752
    v_mfma_f32_16x16x32_bf16 v[212:215], v[96:99], v[56:59], v[212:215]
    ds_read_b64_tr_b16 v[252:253], v17 offset:1632
    v_mfma_f32_16x16x32_bf16 v[216:219], v[24:27], v[56:59], v[216:219]
    ds_read_b64_tr_b16 v[254:255], v18 offset:1632
    s_waitcnt lgkmcnt(12)
    v_mfma_f32_16x16x32_bf16 v[212:215], v[92:95], v[168:171], v[212:215]
    ds_read_b128 v[224:227], v15 offset:2816
    v_mfma_f32_16x16x32_bf16 v[216:219], v[124:127], v[168:171], v[216:219]
    ds_read_b128 v[228:231], v15 offset:2880
    s_waitcnt lgkmcnt(12)
    v_mfma_f32_16x16x32_bf16 v[212:215], v[88:91], v[172:175], v[212:215]
    ds_read_b128 v[232:235], v15 offset:2944
    v_mfma_f32_16x16x32_bf16 v[216:219], v[120:123], v[172:175], v[216:219]
    ds_read_b128 v[236:239], v15 offset:3008
    s_waitcnt lgkmcnt(10)
    v_mfma_f32_16x16x32_bf16 v[208:211], v[188:191], v[160:163], v[208:211]
    ds_read_b128 v[28:31], v15 offset:3072
    v_mfma_f32_16x16x32_bf16 v[212:215], v[188:191], v[152:155], v[212:215]
    ds_read_b128 v[32:35], v15 offset:3136
    v_mfma_f32_16x16x32_bf16 v[216:219], v[188:191], v[144:147], v[216:219]
    ds_read_b64_tr_b16 v[188:189], v17 offset:1904
    s_waitcnt lgkmcnt(12)
    v_mfma_f32_16x16x32_bf16 v[212:215], v[84:87], v[176:179], v[212:215]
    ds_read_b64_tr_b16 v[190:191], v18 offset:1904
    v_mfma_f32_16x16x32_bf16 v[216:219], v[116:119], v[176:179], v[216:219]
    ds_read_b128 v[36:39], v15 offset:3200
    s_waitcnt lgkmcnt(12)
    v_mfma_f32_16x16x32_bf16 v[208:211], v[244:247], v[164:167], v[208:211]
    ds_read_b128 v[40:43], v15 offset:3264
    v_mfma_f32_16x16x32_bf16 v[212:215], v[244:247], v[156:159], v[212:215]
    ds_read_b128 v[44:47], v15 offset:3328
    v_mfma_f32_16x16x32_bf16 v[216:219], v[244:247], v[148:151], v[216:219]
    s_nop 3
    ds_write_b64 v16, v[208:209] offset:4736
    s_waitcnt lgkmcnt(14)
    v_mfma_f32_16x16x32_bf16 v[212:215], v[80:83], v[180:183], v[212:215]
    ds_read_b64_tr_b16 v[244:245], v19 offset:544
    v_mfma_f32_16x16x32_bf16 v[216:219], v[112:115], v[180:183], v[216:219]
    ds_write_b64 v16, v[210:211] offset:5376
    s_waitcnt lgkmcnt(14)
    v_mfma_f32_16x16x32_bf16 v[212:215], v[252:255], v[160:163], v[212:215]
    ds_read_b64_tr_b16 v[246:247], v7 offset:544
    v_mfma_f32_16x16x32_bf16 v[216:219], v[252:255], v[152:155], v[216:219]
    ds_write_b32 v8, v8 offset:64
    v_mfma_f32_16x16x32_bf16 v[220:223], v[252:255], v[144:147], v[220:223]
    ds_read_b64_tr_b16 v[252:253], v17 offset:2176
    s_waitcnt lgkmcnt(15)
    v_mfma_f32_16x16x32_bf16 v[212:215], v[76:79], v[224:227], v[212:215]
    ds_read_b64_tr_b16 v[254:255], v18 offset:2176
    v_mfma_f32_16x16x32_bf16 v[216:219], v[108:111], v[224:227], v[216:219]
    ds_read_b128 v[48:51], v15 offset:3392
    s_waitcnt lgkmcnt(11)
    v_mfma_f32_16x16x32_bf16 v[212:215], v[188:191], v[164:167], v[212:215]
    ds_read_b128 v[52:55], v15 offset:3456
    v_mfma_f32_16x16x32_bf16 v[216:219], v[188:191], v[156:159], v[216:219]
    ds_read_b128 v[56:59], v15 offset:3520
    v_mfma_f32_16x16x32_bf16 v[220:223], v[188:191], v[148:151], v[220:223]
    ds_read_b64_tr_b16 v[188:189], v17 offset:2448
    v_mfma_f32_16x16x32_bf16 v[212:215], v[72:75], v[228:231], v[212:215]
    ds_read_b64_tr_b16 v[190:191], v18 offset:2448
    v_mfma_f32_16x16x32_bf16 v[216:219], v[104:107], v[228:231], v[216:219]
    ds_read_b128 v[168:171], v15 offset:3584
    s_waitcnt lgkmcnt(9)
    v_mfma_f32_16x16x32_bf16 v[212:215], v[244:247], v[140:143], v[212:215]
    ds_read_b128 v[172:175], v15 offset:3648
    v_mfma_f32_16x16x32_bf16 v[216:219], v[244:247], v[136:139], v[216:219]
    ds_read_b128 v[176:179], v15 offset:3712
    v_mfma_f32_16x16x32_bf16 v[220:223], v[244:247], v[132:135], v[220:223]
    ds_read_b64_tr_b16 v[244:245], v19 offset:1088
    v_mfma_f32_16x16x32_bf16 v[212:215], v[68:71], v[232:235], v[212:215]
    ds_read_b64_tr_b16 v[246:247], v7 offset:1088
    v_mfma_f32_16x16x32_bf16 v[216:219], v[100:103], v[232:235], v[216:219]
    ds_read_b128 v[180:183], v15 offset:3776
    v_mfma_f32_16x16x32_bf16 v[212:215], v[64:67], v[236:239], v[212:215]
    ds_read_b128 v[224:227], v15 offset:3840
    v_mfma_f32_16x16x32_bf16 v[216:219], v[96:99], v[236:239], v[216:219]
    ds_read_b128 v[228:231], v15 offset:3904
    v_mfma_f32_16x16x32_bf16 v[220:223], v[24:27], v[236:239], v[220:223]
    s_nop 3
    ds_write_b64 v16, v[212:213] offset:5920
    v_mfma_f32_16x16x32_bf16 v[216:219], v[92:95], v[28:31], v[216:219]
    ds_read_b128 v[232:235], v15 offset:3968
    v_mfma_f32_16x16x32_bf16 v[220:223], v[124:127], v[28:31], v[220:223]
    ds_write_b64 v16, v[214:215] offset:6560
    v_mfma_f32_16x16x32_bf16 v[216:219], v[88:91], v[32:35], v[216:219]
    ds_read_b128 v[236:239], v15 offset:4032
    v_mfma_f32_16x16x32_bf16 v[220:223], v[120:123], v[32:35], v[220:223]
    ds_write_b32 v8, v8 offset:80
    s_waitcnt lgkmcnt(15)
    v_mfma_f32_16x16x32_bf16 v[216:219], v[252:255], v[160:163], v[216:219]
    v_mfma_f32_16x16x32_bf16 v[220:223], v[252:255], v[152:155], v[220:223]
    ds_read_b64_tr_b16 v[252:253], v17 offset:2720
    v_mfma_f32_16x16x32_bf16 v[216:219], v[84:87], v[36:39], v[216:219]
    ds_read_b64_tr_b16 v[254:255], v18 offset:2720
    v_mfma_f32_16x16x32_bf16 v[220:223], v[116:119], v[36:39], v[220:223]
    v_mfma_f32_16x16x32_bf16 v[216:219], v[80:83], v[40:43], v[216:219]
    v_mfma_f32_16x16x32_bf16 v[220:223], v[112:115], v[40:43], v[220:223]
    s_waitcnt lgkmcnt(15)
    v_mfma_f32_16x16x32_bf16 v[216:219], v[188:191], v[164:167], v[216:219]
    v_mfma_f32_16x16x32_bf16 v[220:223], v[188:191], v[156:159], v[220:223]
    ds_read_b64_tr_b16 v[188:189], v17 offset:2992
    v_mfma_f32_16x16x32_bf16 v[216:219], v[76:79], v[44:47], v[216:219]
    ds_read_b64_tr_b16 v[190:191], v18 offset:2992
    v_mfma_f32_16x16x32_bf16 v[220:223], v[108:111], v[44:47], v[220:223]
    v_mfma_f32_16x16x32_bf16 v[216:219], v[72:75], v[48:51], v[216:219]
    v_mfma_f32_16x16x32_bf16 v[220:223], v[104:107], v[48:51], v[220:223]
    s_waitcnt lgkmcnt(12)
    v_mfma_f32_16x16x32_bf16 v[216:219], v[244:247], v[140:143], v[216:219]
    v_mfma_f32_16x16x32_bf16 v[220:223], v[244:247], v[136:139], v[220:223]
    ds_read_b64_tr_b16 v[244:245], v19 offset:1632
    v_mfma_f32_16x16x32_bf16 v[216:219], v[68:71], v[52:55], v[216:219]
    ds_read_b64_tr_b16 v[246:247], v7 offset:1632
    v_mfma_f32_16x16x32_bf16 v[220:223], v[100:103], v[52:55], v[220:223]
    v_mfma_f32_16x16x32_bf16 v[216:219], v[64:67], v[56:59], v[216:219]
    v_mfma_f32_16x16x32_bf16 v[220:223], v[96:99], v[56:59], v[220:223]
    v_mfma_f32_16x16x32_bf16 v[220:223], v[92:95], v[168:171], v[220:223]
    s_nop 5
    ds_write_b64 v16, v[216:217] offset:7104
    v_mfma_f32_16x16x32_bf16 v[220:223], v[88:91], v[172:175], v[220:223]
    s_waitcnt lgkmcnt(5)
    v_mfma_f32_16x16x32_bf16 v[220:223], v[252:255], v[160:163], v[220:223]
    ds_write_b64 v16, v[218:219] offset:7744
    v_mfma_f32_16x16x32_bf16 v[220:223], v[84:87], v[176:179], v[220:223]
    v_mfma_f32_16x16x32_bf16 v[220:223], v[80:83], v[180:183], v[220:223]
    ds_write_b32 v8, v8 offset:96
    s_waitcnt lgkmcnt(5)
    v_mfma_f32_16x16x32_bf16 v[220:223], v[188:191], v[164:167], v[220:223]
    v_mfma_f32_16x16x32_bf16 v[220:223], v[76:79], v[224:227], v[220:223]
    v_mfma_f32_16x16x32_bf16 v[220:223], v[72:75], v[228:231], v[220:223]
    s_waitcnt lgkmcnt(3)
    v_mfma_f32_16x16x32_bf16 v[220:223], v[244:247], v[140:143], v[220:223]
    v_mfma_f32_16x16x32_bf16 v[220:223], v[68:71], v[232:235], v[220:223]
    v_mfma_f32_16x16x32_bf16 v[220:223], v[64:67], v[236:239], v[220:223]
    s_nop 7
    ds_write_b64 v16, v[220:221] offset:8288
    ds_write_b64 v16, v[222:223] offset:8928
    ds_write_b32 v8, v8 offset:112
    s_endpgm
L_io:
    s_lshl_b32 s4, s48, 2
    s_add_u32 s4, s4, s45
    s_lshl_b32 s4, s4, 7
    s_add_u32 s4, s4, 16384
    v_and_b32_e64 v34, 31, v0
    v_lshl_add_u32 v180, v34, 2, s4
    s_add_u32 s4, s49, 20480
    v_lshl_add_u32 v212, v34, 2, s4
    v_cmp_gt_u32 vcc, 32, v0
    s_add_u32 s4, s47, s45
    s_lshl_b32 s4, s4, 2
    v_cndmask_b32 v221, v212, v180, vcc
    s_lshl_b32 s8, s44, 4
    s_lshl_b32 s8, s8, 3
    s_add_u32 s8, s8, 32768
    v_lshl_add_u32 v217, v0, 3, s8
    v_writelane_b32 v221, s8, 63
    s_add_u32 s4, s4, 16384
    v_mov_b32 v216, s4
    v_add_u32 v223, s22, v184
    v_add_u32 v222, 13312, v223
    v_and_b32 v34, 3, v0
    v_lshrrev_b32 v35, 4, v0
    v_lshlrev_b32 v36, 1, v34
    v_xor_b32 v35, v35, v36
    v_and_b32_e64 v36, 12, v0
    v_lshl_add_u32 v35, v35, 4, v36
    v_lshl_add_u32 v35, v34, 9, v35
    v_xor_b32_e64 v36, 64, v35
    s_add_u32 s4, s22, 13312
    v_add_u32 v177, s4, v35
    v_add_u32 v189, s4, v36
    v_lshrrev_b32 v35, 2, v0
    v_lshlrev_b32 v36, 4, v34
    v_lshl_add_u32 v35, v35, 14, v36
    v_add_u32_e64 v178, s39, v35
    v_add_u32 v179, 0x40000, v178
    v_lshrrev_b32_e64 v35, 3, v0
    v_and_b32 v36, 0x70, v184
    v_lshl_add_u32 v35, v35, 10, v36
    v_add_u32_e64 v213, s38, v35
    v_add_u32 v183, 0x2000, v213
    s_mov_b32 s30, 0x05040100
    s_mov_b32 s31, 0x07060302
    s_sub_u32 s23, s22, 48000
    s_mov_b32 s24, 0x3fb8aa3b
    s_mov_b32 s28, 0
    s_mov_b32 s29, 0x80000000
    v_mov_b32 v32, 0x3c00
    s_mov_b32 m0, s23
    s_nop 0
    ds_write_addtid_b32 v32 offset:48000
    s_setprio 1
    s_waitcnt vmcnt(5)
    v_mul_f32 v33, s24, v33
    v_exp_f32 v33, v33
    s_nop 0
    v_cvt_pk_bf16_f32 v33, v33, v33
    v_lshlrev_b32_e64 v33, 16, v33
    v_and_b32 v42, 0xffff0000, v1
    v_mul_f32 v42, s24, v42
    v_exp_f32 v42, v42
    s_waitcnt vmcnt(4)
    v_and_b32 v43, 0xffff0000, v2
    v_cvt_pk_bf16_f32 v42, v42, v42
    v_mul_f32 v43, v33, v43
    v_lshlrev_b32 v42, 16, v42
    v_mul_f32 v43, 0.15915494, v43
    v_mul_f32_e64 v42, -v33, v42
    v_fract_f32 v40, v43
    v_mul_f32 v42, s24, v42
    v_cos_f32 v36, v40
    v_exp_f32 v46, v42
    v_sin_f32_e64 v37, v40
    global_load_dwordx4 v[240:243], v184, s[6:7] offset:0
    s_add_u32 s6, s6, 7168
    s_addc_u32 s7, s7, 0
    s_nop 0
    global_load_dword v187, v221, s[42:43] sc1
    v_pk_mul_f32 v[36:37], v[36:37], v[46:47] op_sel_hi:[1,0]
    v_cvt_pk_f16_f32 v50, v36, v37
    v_pk_mul_f32 v[40:41], v[36:37], v[36:37] op_sel_hi:[0,1]
    v_pk_fma_f32 v[36:37], v[36:37], v[36:37], v[40:41] op_sel:[1,1,0] op_sel_hi:[1,0,1] neg_lo:[1,0,0]
    v_cvt_pk_f16_f32 v51, v36, v37
    v_pk_mul_f32 v[40:41], v[36:37], v[36:37] op_sel_hi:[0,1]
    v_pk_fma_f32 v[36:37], v[36:37], v[36:37], v[40:41] op_sel:[1,1,0] op_sel_hi:[1,0,1] neg_lo:[1,0,0]
    v_cvt_pk_f16_f32 v52, v36, v37
    v_pk_mul_f32 v[40:41], v[36:37], v[36:37] op_sel_hi:[0,1]
    v_pk_fma_f32 v[36:37], v[36:37], v[36:37], v[40:41] op_sel:[1,1,0] op_sel_hi:[1,0,1] neg_lo:[1,0,0]
    v_cvt_pk_f16_f32 v53, v36, v37
    ds_write_addtid_b32 v53 offset:48272
    v_pk_mul_f32 v[40:41], v[36:37], v[36:37] op_sel_hi:[0,1]
    v_pk_fma_f32 v[36:37], v[36:37], v[36:37], v[40:41] op_sel:[1,1,0] op_sel_hi:[1,0,1] neg_lo:[1,0,0]
    v_cvt_pk_f16_f32 v54, v36, v37
    ds_write_addtid_b32 v54 offset:48544
    v_pk_mul_f32 v[40:41], v[36:37], v[36:37] op_sel_hi:[0,1]
    v_pk_fma_f32 v[36:37], v[36:37], v[36:37], v[40:41] op_sel:[1,1,0] op_sel_hi:[1,0,1] neg_lo:[1,0,0]
    v_cvt_pk_f16_f32 v55, v36, v37
    ds_write_addtid_b32 v55 offset:49088
    v_pk_mul_f32 v[40:41], v[36:37], v[36:37] op_sel_hi:[0,1]
    v_pk_fma_f32 v[36:37], v[36:37], v[36:37], v[40:41] op_sel:[1,1,0] op_sel_hi:[1,0,1] neg_lo:[1,0,0]
    v_cvt_pk_f16_f32 v56, v36, v37
    ds_write_addtid_b32 v56 offset:50176
    v_pk_mul_f32 v[40:41], v[36:37], v[36:37] op_sel_hi:[0,1]
    global_load_dword v215, v188, s[40:41] sc1
    v_pk_fma_f32 v[36:37], v[36:37], v[36:37], v[40:41] op_sel:[1,1,0] op_sel_hi:[1,0,1] neg_lo:[1,0,0]
    v_cvt_pk_f16_f32 v57, v36, v37
    ds_write_addtid_b32 v57 offset:52352
    v_pk_mul_f32 v[40:41], v[36:37], v[36:37] op_sel_hi:[0,1]
    v_pk_fma_f32 v[36:37], v[36:37], v[36:37], v[40:41] op_sel:[1,1,0] op_sel_hi:[1,0,1] neg_lo:[1,0,0]
    v_cvt_pk_f16_f32 v58, v36, v37
    s_waitcnt vmcnt(6)
    ds_write_b128 v222, v[204:207]
    s_waitcnt vmcnt(5)
    ds_write_b128 v222, v[208:211] offset:1024
    ds_read2_b32 v[204:205], v177 offset0:0 offset1:32
    ds_read2_b32 v[206:207], v177 offset0:64 offset1:96
    ds_read2_b32 v[208:209], v189 offset0:0 offset1:32
    ds_read2_b32 v[210:211], v189 offset0:64 offset1:96
    v_pk_mul_f32 v[40:41], v[36:37], v[36:37] op_sel_hi:[0,1]
    v_pk_fma_f32 v[36:37], v[36:37], v[36:37], v[40:41] op_sel:[1,1,0] op_sel_hi:[1,0,1] neg_lo:[1,0,0]
    v_cvt_pk_f16_f32 v59, v36, v37
    v_pk_mul_f32 v[40:41], v[36:37], v[36:37] op_sel_hi:[0,1]
    v_pk_fma_f32 v[36:37], v[36:37], v[36:37], v[40:41] op_sel:[1,1,0] op_sel_hi:[1,0,1] neg_lo:[1,0,0]
    v_cvt_pk_f16_f32 v60, v36, v37
    s_waitcnt lgkmcnt(2)
    global_store_dwordx4 v178, v[204:207], s[62:63]
    s_waitcnt lgkmcnt(0)
    global_store_dwordx4 v179, v[208:211], s[62:63]
    v_pk_mul_f16 v147, v53, v54 op_sel_hi:[0,1]
    v_pk_fma_f16 v147, v53, v54, v147 op_sel:[1,1,0] op_sel_hi:[1,0,1] neg_lo:[1,0,0]
    ds_write_addtid_b32 v147 offset:48816
    v_pk_mul_f16 v149, v53, v55 op_sel_hi:[0,1]
    v_pk_fma_f16 v149, v53, v55, v149 op_sel:[1,1,0] op_sel_hi:[1,0,1] neg_lo:[1,0,0]
    ds_write_addtid_b32 v149 offset:49360
    v_pk_mul_f16 v150, v54, v55 op_sel_hi:[0,1]
    v_pk_fma_f16 v150, v54, v55, v150 op_sel:[1,1,0] op_sel_hi:[1,0,1] neg_lo:[1,0,0]
    ds_write_addtid_b32 v150 offset:49632
    v_pk_mul_f16 v151, v147, v55 op_sel_hi:[0,1]
    v_pk_fma_f16 v151, v147, v55, v151 op_sel:[1,1,0] op_sel_hi:[1,0,1] neg_lo:[1,0,0]
    ds_write_addtid_b32 v151 offset:49904
    v_pk_mul_f16 v153, v53, v56 op_sel_hi:[0,1]
    v_pk_fma_f16 v153, v53, v56, v153 op_sel:[1,1,0] op_sel_hi:[1,0,1] neg_lo:[1,0,0]
    ds_write_addtid_b32 v153 offset:50448
    v_pk_mul_f16 v154, v54, v56 op_sel_hi:[0,1]
    v_pk_fma_f16 v154, v54, v56, v154 op_sel:[1,1,0] op_sel_hi:[1,0,1] neg_lo:[1,0,0]
    ds_write_addtid_b32 v154 offset:50720
    v_pk_mul_f16 v155, v147, v56 op_sel_hi:[0,1]
    v_pk_fma_f16 v155, v147, v56, v155 op_sel:[1,1,0] op_sel_hi:[1,0,1] neg_lo:[1,0,0]
    ds_write_addtid_b32 v155 offset:50992
    v_pk_mul_f16 v156, v55, v56 op_sel_hi:[0,1]
    s_waitcnt vmcnt(6)
    v_and_b32 v34, 0x7fff7fff, v3
    v_pk_fma_f16 v156, v55, v56, v156 op_sel:[1,1,0] op_sel_hi:[1,0,1] neg_lo:[1,0,0]
    ds_write_addtid_b32 v156 offset:51264
    v_pk_mul_f16 v157, v149, v56 op_sel_hi:[0,1]
    s_waitcnt vmcnt(5)
    v_and_b32 v35, 0x7fff7fff, v4
    v_pk_fma_f16 v157, v149, v56, v157 op_sel:[1,1,0] op_sel_hi:[1,0,1] neg_lo:[1,0,0]
    ds_write_addtid_b32 v157 offset:51536
    v_pk_mul_f16 v158, v150, v56 op_sel_hi:[0,1]
    v_pk_max_u16 v34, v34, v35
    v_pk_fma_f16 v158, v150, v56, v158 op_sel:[1,1,0] op_sel_hi:[1,0,1] neg_lo:[1,0,0]
    ds_write_addtid_b32 v158 offset:51808
    v_pk_mul_f16 v159, v151, v56 op_sel_hi:[0,1]
    v_lshrrev_b32_e64 v35, 16, v34
    v_pk_fma_f16 v159, v151, v56, v159 op_sel:[1,1,0] op_sel_hi:[1,0,1] neg_lo:[1,0,0]
    ds_write_addtid_b32 v159 offset:52080
    v_pk_mul_f16 v163, v53, v57 op_sel_hi:[0,1]
    v_and_b32 v34, 0xffff, v34
    v_pk_fma_f16 v163, v53, v57, v163 op_sel:[1,1,0] op_sel_hi:[1,0,1] neg_lo:[1,0,0]
    ds_write_addtid_b32 v163 offset:52624
    v_pk_mul_f16 v160, v54, v57 op_sel_hi:[0,1]
    v_max_u32_e64 v34, v34, v35
    v_pk_fma_f16 v160, v54, v57, v160 op_sel:[1,1,0] op_sel_hi:[1,0,1] neg_lo:[1,0,0]
    ds_write_addtid_b32 v160 offset:52896
    v_pk_mul_f16 v161, v147, v57 op_sel_hi:[0,1]
    v_max_u32_dpp v34, v34, v34 row_shr:1 row_mask:0xf bank_mask:0xf
    v_pk_fma_f16 v161, v147, v57, v161 op_sel:[1,1,0] op_sel_hi:[1,0,1] neg_lo:[1,0,0]
    ds_write_addtid_b32 v161 offset:53168
    v_pk_mul_f16 v162, v55, v57 op_sel_hi:[0,1]
    v_max_u32_dpp v34, v34, v34 row_shr:2 row_mask:0xf bank_mask:0xf
    v_pk_fma_f16 v162, v55, v57, v162 op_sel:[1,1,0] op_sel_hi:[1,0,1] neg_lo:[1,0,0]
    ds_write_addtid_b32 v162 offset:53440
    v_pk_mul_f16 v163, v149, v57 op_sel_hi:[0,1]
    v_max_u32_dpp v34, v34, v34 row_shr:4 row_mask:0xf bank_mask:0xf
    v_pk_fma_f16 v163, v149, v57, v163 op_sel:[1,1,0] op_sel_hi:[1,0,1] neg_lo:[1,0,0]
    ds_write_addtid_b32 v163 offset:53712
    v_pk_mul_f16 v160, v150, v57 op_sel_hi:[0,1]
    v_max_u32_dpp v34, v34, v34 row_shr:8 row_mask:0xf bank_mask:0xf
    v_pk_fma_f16 v160, v150, v57, v160 op_sel:[1,1,0] op_sel_hi:[1,0,1] neg_lo:[1,0,0]
    s_waitcnt vmcnt(0)
    v_cmp_eq_u32 vcc, 0, v215
    s_mov_b32 s33, 0
    s_cbranch_vccz L_io4
L_io3:
    s_sleep 2
    s_add_u32 s33, s33, 1
    s_cmp_gt_u32 s33, 0x40000
    s_cbranch_scc1 L_io4
    global_load_dword v215, v188, s[40:41] sc1
    s_waitcnt vmcnt(0)
    v_cmp_eq_u32 vcc, 0, v215
    s_cbranch_vccnz L_io3
L_io4:
    v_lshl_add_u32 v219, s54, 1, v215
    s_mov_b64 exec, 1
    global_store_dword v216, v219, s[42:43]
    s_mov_b64 exec, -1
    v_add_u32 v240, s22, v240
    v_add_u32 v241, s22, v241
    ds_write_addtid_b32 v160 offset:53984
    v_pk_mul_f16 v161, v151, v57 op_sel_hi:[0,1]
    global_load_dwordx4 v[8:11], v184, s[6:7] offset:-2048
    v_max_u32_dpp v34, v34, v34 row_bcast:15 row_mask:0xa bank_mask:0xf
    v_pk_fma_f16 v161, v151, v57, v161 op_sel:[1,1,0] op_sel_hi:[1,0,1] neg_lo:[1,0,0]
    ds_write_addtid_b32 v161 offset:54256
    global_load_dwordx4 v[12:15], v184, s[6:7] offset:-1024
    v_pk_mul_f16 v162, v56, v57 op_sel_hi:[0,1]
    v_max_u32_dpp v34, v34, v34 row_bcast:31 row_mask:0xc bank_mask:0xf
    v_pk_fma_f16 v162, v56, v57, v162 op_sel:[1,1,0] op_sel_hi:[1,0,1] neg_lo:[1,0,0]
    global_load_dwordx4 v[16:19], v184, s[6:7] offset:0
    ds_write_addtid_b32 v162 offset:54528
    v_pk_mul_f16 v163, v153, v57 op_sel_hi:[0,1]
    v_readlane_b32 s34, v34, 63
    global_load_dwordx4 v[20:23], v184, s[6:7] offset:1024
    v_pk_fma_f16 v163, v153, v57, v163 op_sel:[1,1,0] op_sel_hi:[1,0,1] neg_lo:[1,0,0]
    ds_write_addtid_b32 v163 offset:54800
    v_pk_mul_f16 v160, v154, v57 op_sel_hi:[0,1]
    global_load_dwordx4 v[24:27], v184, s[6:7] offset:2048
    s_lshr_b32 s34, s34, 7
    s_max_u32 s34, s34, 11
    s_sub_u32 s36, 264, s34
    s_lshl_b32 s36, s36, 23
    s_mov_b32 s37, s36
    s_sub_u32 s35, s34, 9
    s_lshl_b32 s35, s35, 23
    v_pk_fma_f16 v160, v154, v57, v160 op_sel:[1,1,0] op_sel_hi:[1,0,1] neg_lo:[1,0,0]
    ds_write_addtid_b32 v160 offset:55072
    global_load_dwordx4 v[28:31], v184, s[6:7] offset:3072
    v_pk_mul_f16 v161, v155, v57 op_sel_hi:[0,1]
    v_mul_f32_e64 v62, s35, v33
    v_pk_fma_f16 v161, v155, v57, v161 op_sel:[1,1,0] op_sel_hi:[1,0,1] neg_lo:[1,0,0]
    ds_write_addtid_b32 v161 offset:55344
    v_pk_mul_f16 v162, v156, v57 op_sel_hi:[0,1]
    v_pk_fma_f16 v162, v156, v57, v162 op_sel:[1,1,0] op_sel_hi:[1,0,1] neg_lo:[1,0,0]
    ds_write_addtid_b32 v162 offset:55616
    v_pk_mul_f16 v163, v157, v57 op_sel_hi:[0,1]
    v_pk_fma_f16 v163, v157, v57, v163 op_sel:[1,1,0] op_sel_hi:[1,0,1] neg_lo:[1,0,0]
    ds_write_addtid_b32 v163 offset:55888
    v_pk_mul_f16 v160, v158, v57 op_sel_hi:[0,1]
    v_pk_fma_f16 v160, v158, v57, v160 op_sel:[1,1,0] op_sel_hi:[1,0,1] neg_lo:[1,0,0]
    ds_write_addtid_b32 v160 offset:56160
    v_pk_mul_f16 v161, v159, v57 op_sel_hi:[0,1]
    v_pk_fma_f16 v161, v159, v57, v161 op_sel:[1,1,0] op_sel_hi:[1,0,1] neg_lo:[1,0,0]
    ds_write_addtid_b32 v161 offset:56432
    v_and_b32 v40, 0xffff0000, v3
    v_and_b32 v41, 0xffff0000, v4
    v_pk_mul_f32 v[40:41], v[40:41], s[36:37]
    v_cvt_pk_f16_f32 v164, v40, -v41
    ds_write_addtid_b32 v164 offset:57792
    ds_read_b128 v[96:99], v240 offset:0
    v_pk_mul_f16 v162, v164, v50 op_sel_hi:[0,1] neg_hi:[0,1]
    v_pk_fma_f16 v162, v164, v50, v162 op_sel:[1,1,0] op_sel_hi:[1,0,1]
    ds_write_addtid_b32 v162 offset:58064
    v_pk_mul_f16 v165, v164, v51 op_sel_hi:[0,1] neg_hi:[0,1]
    v_pk_fma_f16 v165, v164, v51, v165 op_sel:[1,1,0] op_sel_hi:[1,0,1]
    ds_write_addtid_b32 v165 offset:58336
    ds_read_b128 v[100:103], v240 offset:32
    v_pk_mul_f16 v160, v165, v50 op_sel_hi:[0,1] neg_hi:[0,1]
    v_pk_fma_f16 v160, v165, v50, v160 op_sel:[1,1,0] op_sel_hi:[1,0,1]
    ds_write_addtid_b32 v160 offset:58608
    v_pk_mul_f16 v166, v164, v52 op_sel_hi:[0,1] neg_hi:[0,1]
    v_pk_fma_f16 v166, v164, v52, v166 op_sel:[1,1,0] op_sel_hi:[1,0,1]
    ds_write_addtid_b32 v166 offset:56704
    ds_read_b128 v[104:107], v240 offset:64
    v_pk_mul_f16 v162, v166, v50 op_sel_hi:[0,1] neg_hi:[0,1]
    v_pk_fma_f16 v162, v166, v50, v162 op_sel:[1,1,0] op_sel_hi:[1,0,1]
    ds_write_addtid_b32 v162 offset:56976
    v_pk_mul_f16 v167, v166, v51 op_sel_hi:[0,1] neg_hi:[0,1]
    v_pk_fma_f16 v167, v166, v51, v167 op_sel:[1,1,0] op_sel_hi:[1,0,1]
    ds_write_addtid_b32 v167 offset:57248
    ds_read_b128 v[108:111], v240 offset:96
    v_pk_mul_f16 v160, v167, v50 op_sel_hi:[0,1] neg_hi:[0,1]
    v_pk_fma_f16 v160, v167, v50, v160 op_sel:[1,1,0] op_sel_hi:[1,0,1]
    ds_write_addtid_b32 v160 offset:57520
    v_pk_mul_f16 v168, v164, v53 op_sel_hi:[0,1] neg_hi:[0,1]
    v_pk_fma_f16 v168, v164, v53, v168 op_sel:[1,1,0] op_sel_hi:[1,0,1]
    ds_write_addtid_b32 v168 offset:58880
    ds_read_b128 v[112:115], v240 offset:128
    v_pk_mul_f16 v162, v168, v50 op_sel_hi:[0,1] neg_hi:[0,1]
    v_pk_fma_f16 v162, v168, v50, v162 op_sel:[1,1,0] op_sel_hi:[1,0,1]
    ds_write_addtid_b32 v162 offset:59152
    v_pk_mul_f16 v169, v168, v51 op_sel_hi:[0,1] neg_hi:[0,1]
    v_pk_fma_f16 v169, v168, v51, v169 op_sel:[1,1,0] op_sel_hi:[1,0,1]
    ds_write_addtid_b32 v169 offset:59424
    ds_read_b128 v[116:119], v240 offset:160
    v_pk_mul_f16 v160, v164, v58 op_sel_hi:[0,1] neg_hi:[0,1]
    v_pk_fma_f16 v160, v164, v58, v160 op_sel:[1,1,0] op_sel_hi:[1,0,1]
    ds_write_addtid_b32 v160 offset:62144
    v_pk_mul_f16 v161, v165, v58 op_sel_hi:[0,1] neg_hi:[0,1]
    v_pk_fma_f16 v161, v165, v58, v161 op_sel:[1,1,0] op_sel_hi:[1,0,1]
    ds_write_addtid_b32 v161 offset:59968
    ds_read_b128 v[120:123], v240 offset:192
    v_pk_mul_f16 v162, v166, v58 op_sel_hi:[0,1] neg_hi:[0,1]
    v_pk_fma_f16 v162, v166, v58, v162 op_sel:[1,1,0] op_sel_hi:[1,0,1]
    ds_write_addtid_b32 v162 offset:60240
    v_pk_mul_f16 v163, v167, v58 op_sel_hi:[0,1] neg_hi:[0,1]
    v_pk_fma_f16 v163, v167, v58, v163 op_sel:[1,1,0] op_sel_hi:[1,0,1]
    ds_write_addtid_b32 v163 offset:60512
    ds_read_b128 v[124:127], v240 offset:224
    v_pk_mul_f16 v170, v168, v58 op_sel_hi:[0,1] neg_hi:[0,1]
    v_pk_fma_f16 v170, v168, v58, v170 op_sel:[1,1,0] op_sel_hi:[1,0,1]
    ds_write_addtid_b32 v170 offset:60784
    v_pk_mul_f16 v161, v169, v58 op_sel_hi:[0,1] neg_hi:[0,1]
    v_pk_fma_f16 v161, v169, v58, v161 op_sel:[1,1,0] op_sel_hi:[1,0,1]
    ds_write_addtid_b32 v161 offset:61056
    v_pk_mul_f16 v171, v166, v59 op_sel_hi:[0,1] neg_hi:[0,1]
    v_pk_fma_f16 v171, v166, v59, v171 op_sel:[1,1,0] op_sel_hi:[1,0,1]
    ds_write_addtid_b32 v171 offset:61600
    v_pk_mul_f16 v172, v168, v59 op_sel_hi:[0,1] neg_hi:[0,1]
    global_load_dword v221, v180, s[42:43] sc1
    v_pk_fma_f16 v172, v168, v59, v172 op_sel:[1,1,0] op_sel_hi:[1,0,1]
    ds_write_addtid_b32 v172 offset:61328
    v_pk_mul_f16 v160, v171, v58 op_sel_hi:[0,1] neg_hi:[0,1]
    v_pk_fma_f16 v160, v171, v58, v160 op_sel:[1,1,0] op_sel_hi:[1,0,1]
    ds_write_addtid_b32 v160 offset:62688
    v_pk_mul_f16 v173, v172, v58 op_sel_hi:[0,1] neg_hi:[0,1]
    v_pk_fma_f16 v173, v172, v58, v173 op_sel:[1,1,0] op_sel_hi:[1,0,1]
    ds_write_addtid_b32 v173 offset:62416
    v_pk_mul_f16 v162, v168, v60 op_sel_hi:[0,1] neg_hi:[0,1]
    v_pk_fma_f16 v162, v168, v60, v162 op_sel:[1,1,0] op_sel_hi:[1,0,1]
    ds_write_addtid_b32 v162 offset:61872
    v_pk_mul_f16 v163, v170, v60 op_sel_hi:[0,1] neg_hi:[0,1]
    v_pk_fma_f16 v163, v170, v60, v163 op_sel:[1,1,0] op_sel_hi:[1,0,1]
    ds_write_addtid_b32 v163 offset:62960
    v_pk_mul_f16 v160, v172, v60 op_sel_hi:[0,1] neg_hi:[0,1]
    v_pk_fma_f16 v160, v172, v60, v160 op_sel:[1,1,0] op_sel_hi:[1,0,1]
    ds_write_addtid_b32 v160 offset:59696
    v_pk_mul_f16 v161, v173, v60 op_sel_hi:[0,1] neg_hi:[0,1]
    v_pk_fma_f16 v161, v173, v60, v161 op_sel:[1,1,0] op_sel_hi:[1,0,1]
    ds_write_addtid_b32 v161 offset:63232
    ds_read_b128 v[64:67], v241 offset:0
    ds_read_b128 v[68:71], v241 offset:32
    ds_read_b128 v[72:75], v241 offset:64
    ds_read_b128 v[76:79], v241 offset:96
    ds_read_b128 v[80:83], v241 offset:128
    ds_read_b128 v[84:87], v241 offset:160
    ds_read_b128 v[88:91], v241 offset:192
    ds_read_b128 v[92:95], v241 offset:224
    s_waitcnt lgkmcnt(7)
    v_mfma_f32_32x32x16_f16 v[128:143], v[64:67], v[96:99], 0
    s_mov_b32 s25, 0
    s_waitcnt vmcnt(0)
    v_cmp_ne_u32 vcc, v221, v219
    s_cbranch_vccnz L_try1a
    global_load_dwordx4 v[224:227], v213, s[62:63] sc1
    global_load_dwordx4 v[228:231], v183, s[62:63] sc1
    s_mov_b32 s25, 1
    s_branch L_try1b
L_try1a:
    global_load_dword v221, v180, s[42:43] sc1
L_try1b:
    s_lshl_b32 s4, s45, 10
    s_add_u32 s4, s4, 124512
    v_lshl_add_u32 v246, v0, 3, s4
    s_lshl_b32 s4, s45, 2
    s_add_u32 s4, s4, 159872
    v_mov_b32 v235, s4
    s_waitcnt lgkmcnt(6)
    v_mfma_f32_32x32x16_f16 v[128:143], v[68:71], v[100:103], v[128:143]
    v_mov_b32 v234, 1
    v_mov_b32_e64 v232, 0
    ds_write_b32 v235, v232
    v_mov_b32 v233, 0
    s_lshl_b32 s4, s45, 3
    s_add_u32 s4, s4, 160064
    s_waitcnt lgkmcnt(6)
    v_mfma_f32_32x32x16_f16 v[128:143], v[72:75], v[104:107], v[128:143]
    v_mov_b32 v245, s4
    s_mul_i32 s23, s45, 6656
    s_add_u32 s23, s23, 133248
    v_add_u32 v243, s23, v243
    v_mov_b32 v63, s23
    v_lshlrev_b32 v44, 2, v0
    s_waitcnt lgkmcnt(5)
    v_mfma_f32_32x32x16_f16 v[128:143], v[76:79], v[108:111], v[128:143]
    s_add_u32 s4, s23, 5756
    v_sub_u32 v242, s4, v44
    v_lshlrev_b32 v44, 1, v0
    s_add_u32 s4, s23, 6018
    v_sub_u32_e64 v244, s4, v44
    s_add_u32 s4, s47, 24576
    s_cmp_lg_u32 s25, 0
    s_cbranch_scc1 L_try3b
    s_waitcnt vmcnt(0)
    v_cmp_ne_u32 vcc, v221, v219
    s_cbranch_vccnz L_try3a
    global_load_dwordx4 v[224:227], v213, s[62:63] sc1
    global_load_dwordx4 v[228:231], v183, s[62:63] sc1
    s_mov_b32 s25, 1
    s_branch L_try3b
L_try3a:
    global_load_dword v221, v180, s[42:43] sc1
L_try3b:
    s_waitcnt lgkmcnt(4)
    v_mfma_f32_32x32x16_f16 v[128:143], v[80:83], v[112:115], v[128:143]
    v_mov_b32_e64 v218, s4
    v_add_u32 v181, 4096, v212
    s_waitcnt lgkmcnt(3)
    v_mfma_f32_32x32x16_f16 v[128:143], v[84:87], v[116:119], v[128:143]
    s_waitcnt lgkmcnt(2)
    v_mfma_f32_32x32x16_f16 v[128:143], v[88:91], v[120:123], v[128:143]
    s_waitcnt lgkmcnt(0)
    s_cmp_eq_u32 s25, 0
    s_cbranch_scc1 L_nost
    s_waitcnt vmcnt(1)
    v_perm_b32 v236, v225, v224, s30
    v_perm_b32 v237, v227, v226, s30
    v_perm_b32 v238, v225, v224, s31
    v_perm_b32 v239, v227, v226, s31
    ds_write_b64 v246, v[236:237] offset:0
    ds_write_b64 v246, v[238:239] offset:4608
    s_waitcnt vmcnt(0)
    v_perm_b32 v236, v229, v228, s30
    v_perm_b32 v237, v231, v230, s30
    v_perm_b32 v238, v229, v228, s31
    v_perm_b32 v239, v231, v230, s31
    ds_write_b64 v246, v[236:237] offset:512
    ds_write_b64 v246, v[238:239] offset:5120
    ds_write_b32 v235, v234
L_nost:
    v_mfma_f32_32x32x16_f16 v[128:143], v[92:95], v[124:127], v[128:143]
    s_nop 11
    ds_write_b128 v223, v[128:131]
    ds_write_b128 v223, v[132:135] offset:1024
    v_pk_mul_f32 v[136:137], v[136:137], v[62:63] op_sel_hi:[1,0]
    v_pk_mul_f32 v[138:139], v[138:139], v[62:63] op_sel_hi:[1,0]
    v_pk_mul_f32 v[140:141], v[140:141], v[62:63] op_sel_hi:[1,0]
    v_pk_mul_f32 v[142:143], v[142:143], v[62:63] op_sel_hi:[1,0]
    s_waitcnt lgkmcnt(0)
    s_barrier
    v_subrev_u32 v223, 62016, v223
    ds_read_b128 v[152:155], v223
    ds_read_b128 v[156:159], v223 offset:1024
    s_cmp_lg_u32 s25, 0
    s_cbranch_scc1 L_try2b
    s_waitcnt vmcnt(0)
    v_cmp_ne_u32 vcc, v221, v219
    s_cbranch_vccnz L_try2a
    global_load_dwordx4 v[224:227], v213, s[62:63] sc1
    global_load_dwordx4 v[228:231], v183, s[62:63] sc1
    s_mov_b32 s25, 2
    s_branch L_try2b
L_try2a:
    global_load_dword v221, v180, s[42:43] sc1
L_try2b:
    s_cmp_lg_u32 s45, 0
    s_cbranch_scc1 L_gpub
    s_mov_b64 exec, 15
    v_lshl_add_u32 v236, v0, 2, v235
    ds_read_b32 v214, v236 offset:48
    s_waitcnt lgkmcnt(0)
    s_waitcnt lgkmcnt(0)
    global_store_dwordx2 v217, v[214:215], s[42:43] sc1
    s_mov_b64 exec, -1
L_gpub:
    s_waitcnt lgkmcnt(1)
    v_pk_fma_f32 v[136:137], v[152:153], v[62:63], v[136:137] op_sel_hi:[1,0,1]
    v_pk_fma_f32 v[138:139], v[154:155], v[62:63], v[138:139] op_sel_hi:[1,0,1]
    s_waitcnt lgkmcnt(0)
    s_nop 0
    v_pk_fma_f32 v[140:141], v[156:157], v[62:63], v[140:141] op_sel_hi:[1,0,1]
    v_pk_fma_f32 v[142:143], v[158:159], v[62:63], v[142:143] op_sel_hi:[1,0,1]
    v_cndmask_b32_e64 v139, v139, v138, s[28:29]
    v_cvt_pk_bf16_f32 v161, 0, v138
    v_cvt_pk_bf16_f32 v152, v138, v137
    v_cvt_pk_bf16_f32 v153, v136, v136
    v_cvt_pk_bf16_f32 v154, v138, v138
    v_cvt_pk_bf16_f32 v155, v137, v136
    v_cvt_pk_bf16_f32 v156, v138, v138
    v_cvt_pk_bf16_f32 v157, v138, v137
    v_cvt_pk_bf16_f32 v158, v139, v138
    v_cvt_pk_bf16_f32 v159, v138, v138
    v_cvt_pk_bf16_f32 v162, v140, v141
    v_cvt_pk_bf16_f32 v163, v142, v143
    s_add_u32 s9, s45, 3
    s_and_b32 s9, s9, 3
    s_lshl_b32 s4, s9, 9
    v_add_u32 v24, s4, v24
    s_mul_i32 s4, s9, 544
    v_add_u32 v25, s4, v25
    v_add_u32 v26, s4, v26
    s_mul_i32 s4, s45, 1184
    v_add_u32 v28, s4, v28
    s_lshl_b32 s4, s45, 12
    v_add_u32 v29, s4, v29
    v_add_u32 v30, s22, v30
    v_add_u32_e64 v31, s22, v31
    ds_write_b64 v243, v[152:153] offset:4040
    ds_write_b64 v243, v[154:155] offset:0
    ds_write_b64 v243, v[156:157] offset:1344
    ds_write_b64 v243, v[158:159] offset:2688
    s_mov_b64 exec, s[28:29]
    ds_write_b32 v63, v161 offset:4088
    ds_write_b32 v63, v154 offset:4092
    ds_write_b32 v63, v154 offset:52
    ds_write_b32 v63, v161 offset:1396
    s_mov_b64 exec, -1
    ds_write_b32 v242, v162
    ds_write_b16 v244, v163 offset:128
    ds_write_b16_d16_hi v244, v163 offset:0
    ds_write_b16 v244, v163 offset:516
    ds_write_b16_d16_hi v244, v163 offset:388
    v_perm_b32 v236, v162, v162, s30
    v_mov_b32 v237, 1
    s_mov_b64 exec, s[28:29]
    ds_write_b64 v245, v[236:237]
    s_mov_b64 exec, -1
    s_cmp_eq_u32 s25, 1
    s_cbranch_scc1 L_join
    s_cmp_eq_u32 s25, 2
    s_cbranch_scc1 L_have
    s_waitcnt vmcnt(0)
    s_mov_b32 s33, 0
L_poll:
    global_load_dword v221, v180, s[42:43] sc1
    s_add_u32 s33, s33, 1
    s_waitcnt vmcnt(0)
    v_cmp_ne_u32 vcc, v221, v219
    s_cbranch_vccz L_fast
    s_and_b32 s4, s33, 15
    s_cbranch_scc1 L_poll
    s_mov_b64 exec, 1
    global_store_dword v218, v219, s[42:43] sc1
    s_mov_b64 exec, -1
    global_load_dword v222, v181, s[42:43] sc1
    s_cmp_gt_u32 s33, 0x40000
    s_cbranch_scc1 L_slow
    s_waitcnt vmcnt(0)
    v_sub_u32 v222, v222, v215
    v_bfe_u32 v220, v222, 1, 4
    v_and_b32 v222, 0xffffffe1, v222
    v_cmp_ne_u32 s[12:13], s54, v220
    v_cmp_eq_u32 vcc, 0, v222
    s_and_b64 vcc, vcc, s[12:13]
    s_cbranch_vccnz L_slow
    s_branch L_poll
L_slow:
    s_lshl_b32 s4, s45, 19
    s_add_u32 s4, s4, s47
    v_lshl_add_u32 v222, v0, 12, s4
    s_mov_b32 s23, 0x40000
    buffer_load_dword v224, v222, s[56:59], 0 offen offset:0
    buffer_load_dword v225, v222, s[56:59], 0 offen offset:1024
    buffer_load_dword v226, v222, s[56:59], 0 offen offset:2048
    buffer_load_dword v227, v222, s[56:59], 0 offen offset:3072
    buffer_load_dword v228, v222, s[56:59], s23 offen offset:0
    buffer_load_dword v229, v222, s[56:59], s23 offen offset:1024
    buffer_load_dword v230, v222, s[56:59], s23 offen offset:2048
    buffer_load_dword v231, v222, s[56:59], s23 offen offset:3072
    s_waitcnt vmcnt(0)
    s_branch L_have
L_fast:
    global_load_dwordx4 v[224:227], v213, s[62:63] sc1
    global_load_dwordx4 v[228:231], v183, s[62:63] sc1
L_have:
    s_waitcnt vmcnt(0)
    s_nop 0
    v_perm_b32 v236, v225, v224, s30
    v_perm_b32 v237, v227, v226, s30
    v_perm_b32 v238, v225, v224, s31
    v_perm_b32 v239, v227, v226, s31
    ds_write_b64 v246, v[236:237] offset:0
    ds_write_b64 v246, v[238:239] offset:4608
    v_perm_b32 v236, v229, v228, s30
    v_perm_b32 v237, v231, v230, s30
    v_perm_b32 v238, v229, v228, s31
    v_perm_b32 v239, v231, v230, s31
    ds_write_b64 v246, v[236:237] offset:512
    ds_write_b64 v246, v[238:239] offset:5120
    ds_write_b32 v235, v234
L_join:
    s_setprio 1
    v_add_u32 v76, 0x4000, v29
    s_lshl_b32 s4, s45, 5
    v_mov_b32 v78, s4
    s_cmp_lg_u32 s45, 1
    s_cbranch_scc1 L_uall
    ds_write_b64 v27, v[232:233]
    s_branch L_uall
L_uall0:
    s_sleep 1
L_uall:
    ds_read_b128 v[116:119], v186
    s_waitcnt lgkmcnt(0)
    v_min_u32_e64 v116, v116, v117
    v_min3_u32 v116, v116, v118, v119
    v_cmp_eq_u32 vcc, 0, v116
    s_cbranch_vccnz L_uall0
    v_mov_b32 v116, -1
    v_mov_b32 v117, -1
    v_mov_b32 v118, -1
    v_mov_b32 v119, -1
    global_store_dwordx4 v213, v[116:119], s[62:63]
    global_store_dwordx4 v183, v[116:119], s[62:63]
    s_lshr_b32 s4, s45, 1
    s_sub_u32 s4, 5, s4
    s_sub_u32 s4, s4, s9
    s_mul_i32 s23, s46, 4608
    s_lshl_b32 s8, s4, 9
    s_add_u32 s23, s23, s8
    v_add_u32 v72, s23, v24
    s_mul_i32 s23, s46, 15504
    s_mul_i32 s8, s4, 544
    s_add_u32 s23, s23, s8
    v_add_u32 v73, s23, v25
    v_add_u32 v75, s23, v26
    s_mov_b32 s33, 0
    s_mov_b32 s27, s45
    ds_read_b128 v[80:83], v24
    ds_read_b128 v[84:87], v24 offset:4608
    ds_read_b128 v[88:91], v72
    s_waitcnt lgkmcnt(2)
    v_mfma_f32_16x16x32_bf16 v[140:143], v[8:11], v[80:83], 0
    v_mfma_f32_16x16x32_bf16 v[144:147], v[12:15], v[80:83], 0
    v_mfma_f32_16x16x32_bf16 v[148:151], v[16:19], v[80:83], 0
    v_mfma_f32_16x16x32_bf16 v[152:155], v[20:23], v[80:83], 0
    s_waitcnt lgkmcnt(1)
    v_mfma_f32_16x16x32_bf16 v[156:159], v[8:11], v[84:87], 0
    v_mfma_f32_16x16x32_bf16 v[160:163], v[12:15], v[84:87], 0
    v_mfma_f32_16x16x32_bf16 v[164:167], v[16:19], v[84:87], 0
    v_mfma_f32_16x16x32_bf16 v[168:171], v[20:23], v[84:87], 0
    s_waitcnt lgkmcnt(0)
    v_mfma_f32_16x16x32_bf16 v[172:175], v[8:11], v[88:91], 0
    v_mfma_f32_16x16x32_bf16 v[176:179], v[12:15], v[88:91], 0
    s_setprio 1
    s_nop 0
    v_cvt_pk_bf16_f32 v140, v140, v141
    v_cvt_pk_bf16_f32 v141, v142, v143
    ds_write_b64 v25, v[140:141] offset:0
    v_cvt_pk_bf16_f32 v144, v144, v145
    v_cvt_pk_bf16_f32 v145, v146, v147
    ds_write_b64 v26, v[144:145] offset:3440
    v_cvt_pk_bf16_f32 v148, v148, v149
    v_cvt_pk_bf16_f32 v149, v150, v151
    ds_write_b64 v25, v[148:149] offset:6728
    v_cvt_pk_bf16_f32 v152, v152, v153
    v_cvt_pk_bf16_f32 v153, v154, v155
    ds_write_b64 v25, v[152:153] offset:8920
    v_cvt_pk_bf16_f32 v156, v156, v157
    v_cvt_pk_bf16_f32 v157, v158, v159
    ds_write_b64 v25, v[156:157] offset:15504
    v_cvt_pk_bf16_f32 v160, v160, v161
    v_cvt_pk_bf16_f32 v161, v162, v163
    ds_write_b64 v26, v[160:161] offset:18944
    v_cvt_pk_bf16_f32 v164, v164, v165
    v_cvt_pk_bf16_f32 v165, v166, v167
    ds_write_b64 v25, v[164:165] offset:22232
    v_cvt_pk_bf16_f32 v168, v168, v169
    v_cvt_pk_bf16_f32 v169, v170, v171
    ds_write_b64 v25, v[168:169] offset:24424
    v_cvt_pk_bf16_f32 v172, v172, v173
    v_cvt_pk_bf16_f32 v173, v174, v175
    ds_write_b64 v73, v[172:173] offset:0
    v_cvt_pk_bf16_f32 v176, v176, v177
    v_cvt_pk_bf16_f32 v177, v178, v179
    ds_write_b64 v75, v[176:177] offset:3440
    ds_write_b32 v235, v234 offset:32
    s_waitcnt vmcnt(0)
    ds_write_b32 v235, v234 offset:16
    s_cmp_lg_u32 s45, 0
    s_cbranch_scc1 L_hib
    s_branch L_wall
L_wall0:
    s_sleep 1
L_wall:
    ds_read_b128 v[116:119], v186 offset:16
    s_waitcnt lgkmcnt(0)
    v_min_u32_e64 v116, v116, v117
    v_min3_u32 v116, v116, v118, v119
    v_cmp_eq_u32 vcc, 0, v116
    s_cbranch_vccnz L_wall0
    s_mov_b64 exec, 1
    v_subrev_u32 v74, 4096, v218
    global_store_dword v74, v219, s[42:43]
    s_mov_b64 exec, -1
L_hib:
    global_load_dword v132, v78, s[40:41] sc1
    global_load_dwordx2 v[128:129], v29, s[42:43] sc1
    global_load_dwordx2 v[130:131], v29, s[42:43] offset:2048 sc1
    global_load_dword v138, v78, s[40:41] offset:128 sc1
    global_load_dwordx2 v[134:135], v76, s[42:43] sc1
    global_load_dwordx2 v[136:137], v76, s[42:43] offset:2048 sc1
    s_setprio 1
    v_lshrrev_b32 v36, 3, v0
    v_and_b32 v37, 7, v0
    v_lshlrev_b32 v37, 3, v37
    v_lshl_add_u32 v36, v36, 14, v37
    s_lshl_b32 s4, s46, 18
    s_lshr_b32 s8, s45, 1
    s_lshl_b32 s8, s8, 19
    s_add_u32 s4, s4, s8
    s_lshr_b32 s8, s5, 1
    s_lshl_b32 s8, s8, 10
    s_add_u32 s4, s4, s8
    s_and_b32 s8, s5, 1
    s_lshl_b32 s8, s8, 6
    s_add_u32 s4, s4, s8
    s_add_u32 s4, s4, s49
    v_add_u32 v248, s4, v36
    v_add_u32 v249, 0x20000, v248
    s_lshl_b32 s4, s45, 18
    s_add_u32 s4, s4, s47
    v_lshl_add_u32 v247, v0, 11, s4
    s_mov_b32 s25, 0
    s_waitcnt vmcnt(0)
    global_load_dword v139, v212, s[42:43] sc1
    s_waitcnt vmcnt(0)
L_mode:
    v_cmp_ne_u32 vcc, v139, v219
    s_cbranch_vccz L_mode1
    s_add_u32 s33, s33, 1
    s_sleep 1
    global_load_dword v139, v212, s[42:43] sc1
    s_and_b32 s4, s33, 31
    s_waitcnt vmcnt(0)
    s_cbranch_scc1 L_mode
    s_mov_b64 exec, 1
    global_store_dword v218, v219, s[42:43] sc1
    s_mov_b64 exec, -1
    global_load_dword v222, v181, s[42:43] sc1
    s_cmp_gt_u32 s33, 0x40000
    s_cbranch_scc1 L_spread
    s_waitcnt vmcnt(0)
    v_sub_u32_e64 v222, v222, v215
    v_bfe_u32 v220, v222, 1, 4
    v_and_b32 v222, 0xffffffe1, v222
    v_cmp_ne_u32 s[12:13], s54, v220
    v_cmp_eq_u32 vcc, 0, v222
    s_and_b64 vcc, vcc, s[12:13]
    s_cbranch_vccnz L_spread
    s_branch L_mode
L_mode1:
    s_mov_b32 s25, 1
    s_branch L_fin_loop
L_spread:
    v_add_u32 v116, 4096, v218
    v_add_u32 v117, 4096, v181
    s_cmp_lg_u32 s45, 0
    s_cbranch_scc1 L_clean
    buffer_wbl2 sc1
    s_waitcnt vmcnt(0)
    s_mov_b64 exec, 1
    global_store_dword v116, v215, s[42:43] sc1
    s_mov_b64 exec, -1
L_clean:
    global_load_dword v118, v117, s[42:43] sc1
    s_add_u32 s33, s33, 1
    s_cmp_gt_u32 s33, 0x80000
    s_cbranch_scc1 L_fin_loop
    s_waitcnt vmcnt(0)
    s_waitcnt vmcnt(0)
    v_cmp_ne_u32 vcc, v118, v215
    s_cbranch_vccnz L_clean
L_fin_loop:
    v_cmp_ne_u32 s[34:35], v129, v132
    v_cmp_ne_u32 s[36:37], v131, v132
    v_cmp_eq_u32 vcc, 0, v132
    s_or_b64 s[34:35], s[34:35], s[36:37]
    s_or_b64 vcc, vcc, s[34:35]
    s_cbranch_vccz L_gok
    s_add_u32 s33, s33, 1
    s_cmp_gt_u32 s33, 0x40000
    s_cbranch_scc1 L_gok
    s_sleep 1
    global_load_dword v132, v78, s[40:41] sc1
    global_load_dwordx2 v[128:129], v29, s[42:43] sc1
    global_load_dwordx2 v[130:131], v29, s[42:43] offset:2048 sc1
    s_waitcnt vmcnt(0)
    s_branch L_fin_loop
L_gok:
    v_lshlrev_b32_e64 v96, 16, v128
    v_and_b32 v97, 0xffff0000, v128
    v_lshlrev_b32_e64 v98, 16, v130
    v_and_b32 v99, 0xffff0000, v130
    v_sub_f32 v100, 1.0, v96
    v_sub_f32 v101, 1.0, v97
    v_sub_f32 v102, 1.0, v98
    v_sub_f32 v103, 1.0, v99
    v_cvt_pk_bf16_f32 v101, v100, v101
    v_cvt_pk_bf16_f32 v103, v102, v103
    v_lshlrev_b32_e64 v100, 16, v101
    v_and_b32 v101, 0xffff0000, v101
    v_lshlrev_b32_e64 v102, 16, v103
    v_and_b32 v103, 0xffff0000, v103
    v_add_u32 v104, 0x20000, v247
    s_lshl_b32 s4, s27, 4
    s_add_u32 s4, s4, 159936
    v_mov_b32 v122, s4
    s_min_u32 s4, s4, 160016
    v_mov_b32 v123, s4
    s_branch L_prog1
L_prog:
    s_sleep 4
L_prog1:
    ds_read_b128 v[116:119], v123
    s_waitcnt lgkmcnt(0)
    v_min_u32_e64 v116, v116, v117
    v_min3_u32 v116, v116, v118, v119
    v_cmp_eq_u32 vcc, 0, v116
    s_cbranch_vccnz L_prog
L_prog2:
    ds_read_b128 v[116:119], v122
    ds_read_b64 v[80:81], v28 offset:0
    ds_read_b64 v[84:85], v28 offset:15504
    ds_read_b64 v[88:89], v28 offset:31008
    ds_read_b64 v[92:93], v28 offset:46512
    ds_read_b64 v[82:83], v28 offset:272
    ds_read_b64 v[86:87], v28 offset:15776
    ds_read_b64 v[90:91], v28 offset:31280
    ds_read_b64 v[94:95], v28 offset:46784
    s_waitcnt lgkmcnt(8)
    v_min_u32 v116, v116, v117
    v_min3_u32 v116, v116, v118, v119
    v_cmp_eq_u32 vcc, 0, v116
    s_cbranch_vccnz L_prog2
    s_waitcnt lgkmcnt(7)
    v_mul_f32 v80, v96, v80
    s_waitcnt lgkmcnt(6)
    v_mul_f32 v84, v96, v84
    s_waitcnt lgkmcnt(5)
    v_fmac_f32 v80, v100, v88
    s_waitcnt lgkmcnt(4)
    v_fmac_f32 v84, v100, v92
    v_cvt_pk_bf16_f32 v112, v80, v84
    v_mul_f32 v81, v97, v81
    v_mul_f32 v85, v97, v85
    v_fmac_f32 v81, v101, v89
    v_fmac_f32 v85, v101, v93
    v_cvt_pk_bf16_f32 v113, v81, v85
    s_waitcnt lgkmcnt(3)
    v_mul_f32 v82, v98, v82
    s_waitcnt lgkmcnt(2)
    v_mul_f32 v86, v98, v86
    s_waitcnt lgkmcnt(1)
    v_fmac_f32 v82, v102, v90
    s_waitcnt lgkmcnt(0)
    v_fmac_f32 v86, v102, v94
    v_cvt_pk_bf16_f32 v114, v82, v86
    v_mul_f32 v83, v99, v83
    v_mul_f32 v87, v99, v87
    v_fmac_f32 v83, v103, v91
    v_fmac_f32 v87, v103, v95
    v_cvt_pk_bf16_f32 v115, v83, v87
    s_cmp_eq_u32 s25, 1
    s_cbranch_scc1 L_send
    global_store_dword v247, v112, s[62:63] offset:0 sc0 sc1
    global_store_dword v247, v113, s[62:63] offset:1024 sc0 sc1
    global_store_dword v104, v114, s[62:63] offset:0 sc0 sc1
    global_store_dword v104, v115, s[62:63] offset:1024 sc0 sc1
    s_branch L_next
L_send:
    v_min_u32 v112, -2, v112
    v_min_u32_e64 v113, -2, v113
    global_store_dwordx2 v248, v[112:113], s[62:63]
    v_min_u32 v114, -2, v114
    v_min_u32 v115, -2, v115
    global_store_dwordx2 v249, v[114:115], s[62:63]
L_next:
    v_mov_b32 v128, v134
    v_mov_b32 v129, v135
    v_mov_b32 v130, v136
    v_mov_b32 v131, v137
    v_mov_b32 v132, v138
    v_mov_b32 v29, v76
    v_add_u32 v78, 128, v78
    v_add_u32 v28, 4736, v28
    v_add_u32 v247, 0x100000, v247
    v_add_u32 v248, 0x100000, v248
    v_add_u32 v249, 0x100000, v249
    s_add_u32 s27, s27, 4
    s_cmp_lt_u32 s27, 8
    s_cbranch_scc1 L_fin_loop
    s_cmp_eq_u32 s25, 0
    s_cbranch_scc1 L_fin_out
L_recv:
    global_load_dwordx4 v[80:83], v213, s[62:63] sc1
    global_load_dwordx4 v[84:87], v183, s[62:63] sc1
    s_add_u32 s33, s33, 1
    s_cmp_gt_u32 s33, 0x100000
    s_cbranch_scc1 L_fin_out
    s_waitcnt vmcnt(1)
    ds_write_b128 v30, v[80:83]
    v_max3_u32 v116, v80, v81, v82
    s_waitcnt vmcnt(0)
    ds_write_b128 v30, v[84:87] offset:1088
    v_max3_u32 v117, v84, v85, v86
    v_max3_u32 v116, v116, v83, v87
    v_max_u32 v116, v116, v117
    v_cmp_eq_u32 vcc, -1, v116
    s_cbranch_vccnz L_recv
    ds_read2_b32 v[104:105], v31 offset0:0 offset1:16
    ds_read2_b32 v[106:107], v31 offset0:32 offset1:48
    ds_read2_b32 v[108:109], v31 offset0:8 offset1:24
    ds_read2_b32 v[110:111], v31 offset0:40 offset1:56
    s_waitcnt lgkmcnt(2)
    global_store_dwordx4 v213, v[104:107], s[62:63]
    s_waitcnt lgkmcnt(0)
    global_store_dwordx4 v183, v[108:111], s[62:63]
L_fin_out:
L_end:
    s_endpgm
.p2align 7
L_tab:
.long 0x0, 0x2640, 0x0, 0x230, 0x110, 0x2750, 0x10, 0x220
.long 0x220, 0x2860, 0x20, 0x210, 0x330, 0x2970, 0x30, 0x200
.long 0x440, 0x2200, 0x430, 0x1f0, 0x550, 0x2310, 0x440, 0x1e0
.long 0x660, 0x2420, 0x450, 0x1d0, 0x770, 0x2530, 0x540, 0x1c0
.long 0x880, 0x2200, 0x550, 0x1b0, 0x990, 0x2310, 0x560, 0x1a0
.long 0xaa0, 0x2420, 0x570, 0x190, 0xbb0, 0x2530, 0x970, 0x180
.long 0xcc0, 0x2a80, 0x980, 0x170, 0xdd0, 0x2b90, 0x990, 0x160
.long 0xee0, 0x2ca0, 0xa80, 0x150, 0xff0, 0x2ca0, 0xa90, 0x140
.long 0x1100, 0x3740, 0xaa0, 0x130, 0x1210, 0x2ec0, 0xab0, 0x120
.long 0x1320, 0x2fd0, 0xeb0, 0x110, 0x1430, 0x30e0, 0xec0, 0x100
.long 0x1540, 0x2fd0, 0xed0, 0xf0, 0x1650, 0x30e0, 0xfc0, 0xe0
.long 0x1760, 0x31f0, 0xfd0, 0xd0, 0x1870, 0x3300, 0xfe0, 0xc0
.long 0x1980, 0x3410, 0xff0, 0xb0, 0x1a90, 0x3520, 0x13f0, 0xa0
.long 0x1ba0, 0x3630, 0x1400, 0x90, 0x1cb0, 0x2db0, 0x1410, 0x80
.long 0x1dc0, 0x3850, 0x1500, 0x70, 0x1ed0, 0x3960, 0x1510, 0x60
.long 0x1fe0, 0x3a70, 0x1520, 0x50, 0x20f0, 0x3b80, 0x1530, 0x40
.long 0x10, 0x2650, 0x1540, 0x228, 0x120, 0x2760, 0x1550, 0x218
.long 0x230, 0x2870, 0x1560, 0x208, 0x340, 0x2980, 0x1570, 0x1f8
.long 0x450, 0x2210, 0x1680, 0x1e8, 0x560, 0x2320, 0x1690, 0x1d8
.long 0x670, 0x2430, 0x16a0, 0x1c8, 0x780, 0x2540, 0x16b0, 0x1b8
.long 0x890, 0x2210, 0x16c0, 0x1a8, 0x9a0, 0x2320, 0x16d0, 0x198
.long 0xab0, 0x2430, 0x16e0, 0x188, 0xbc0, 0x2540, 0x16f0, 0x178
.long 0xcd0, 0x2a90, 0x1800, 0x168, 0xde0, 0x2ba0, 0x1810, 0x158
.long 0xef0, 0x2cb0, 0x1820, 0x148, 0x1000, 0x2cb0, 0x1830, 0x138
.long 0x1110, 0x3750, 0x1980, 0x128, 0x1220, 0x2ed0, 0x1990, 0x118
.long 0x1330, 0x2fe0, 0x19a0, 0x108, 0x1440, 0x30f0, 0x19b0, 0xf8
.long 0x1550, 0x2fe0, 0x19b0, 0xe8, 0x1660, 0x30f0, 0x19b0, 0xd8
.long 0x1770, 0x3200, 0x19b0, 0xc8, 0x1880, 0x3310, 0x19b0, 0xb8
.long 0x1990, 0x3420, 0x19b0, 0xa8, 0x1aa0, 0x3530, 0x19b0, 0x98
.long 0x1bb0, 0x3640, 0x19b0, 0x88, 0x1cc0, 0x2dc0, 0x19b0, 0x78
.long 0x1dd0, 0x3860, 0x19b0, 0x68, 0x1ee0, 0x3970, 0x19b0, 0x58
.long 0x1ff0, 0x3a80, 0x19b0, 0x48, 0x2100, 0x3b90, 0x19b0, 0x38
.long 0x3400, 0x0, 0x0, 0x114c8, 0x3620, 0x10, 0x10, 0x114d0
.long 0x3840, 0x20, 0x20, 0x114d8, 0x3a60, 0x30, 0x30, 0x114e0
.long 0x3404, 0x4000, 0x40, 0x11d68, 0x3624, 0x4010, 0x50, 0x11d70
.long 0x3844, 0x4020, 0x60, 0x11d78, 0x3a64, 0x4030, 0x70, 0x11d80
.long 0x3408, 0x8000, 0x400, 0x114e8, 0x3628, 0x8010, 0x410, 0x114f0
.long 0x3848, 0x8020, 0x420, 0x114f8, 0x3a68, 0x8030, 0x430, 0x11500
.long 0x340c, 0xc000, 0x440, 0x11d88, 0x362c, 0xc010, 0x450, 0x11d90
.long 0x384c, 0xc020, 0x460, 0x11da0, 0x3a6c, 0xc030, 0x470, 0x11da8
.long 0x3410, 0x10000, 0x800, 0x11550, 0x3630, 0x10010, 0x810, 0x11558
.long 0x3850, 0x10020, 0x820, 0x11560, 0x3a70, 0x10030, 0x830, 0x11568
.long 0x3414, 0x14000, 0x840, 0x11df0, 0x3634, 0x14010, 0x850, 0x11df8
.long 0x3854, 0x14020, 0x860, 0x11e00, 0x3a74, 0x14030, 0x870, 0x11e08
.long 0x3418, 0x18000, 0xc00, 0x11570, 0x3638, 0x18010, 0xc10, 0x11578
.long 0x3858, 0x18020, 0xc20, 0x11580, 0x3a78, 0x18030, 0xc30, 0x11588
.long 0x341c, 0x1c000, 0xc40, 0x11e10, 0x363c, 0x1c010, 0xc50, 0x11e18
.long 0x385c, 0x1c020, 0xc60, 0x11e28, 0x3a7c, 0x1c030, 0xc70, 0x11e30
.long 0x3420, 0x20000, 0x1000, 0x115d8, 0x3600, 0x20010, 0x1010, 0x115e0
.long 0x3860, 0x20020, 0x1020, 0x115e8, 0x3a40, 0x20030, 0x1030, 0x115f0
.long 0x3424, 0x24000, 0x1040, 0x11e78, 0x3604, 0x24010, 0x1050, 0x11e80
.long 0x3864, 0x24020, 0x1060, 0x11e88, 0x3a44, 0x24030, 0x1070, 0x11e90
.long 0x3428, 0x28000, 0x1400, 0x115f8, 0x3608, 0x28010, 0x1410, 0x11600
.long 0x3868, 0x28020, 0x1420, 0x11608, 0x3a48, 0x28030, 0x1430, 0x11610
.long 0x342c, 0x2c000, 0x1440, 0x11e98, 0x360c, 0x2c010, 0x1450, 0x11ea0
.long 0x386c, 0x2c020, 0x1460, 0x11eb0, 0x3a4c, 0x2c030, 0x1470, 0x11eb8
.long 0x3430, 0x30000, 0x1800, 0x11660, 0x3610, 0x30010, 0x1810, 0x11668
.long 0x3870, 0x30020, 0x1820, 0x11670, 0x3a50, 0x30030, 0x1830, 0x11678
.long 0x3434, 0x34000, 0x1840, 0x11f00, 0x3614, 0x34010, 0x1850, 0x11f08
.long 0x3874, 0x34020, 0x1860, 0x11f10, 0x3a54, 0x34030, 0x1870, 0x11f18
.long 0x3438, 0x38000, 0x1c00, 0x11680, 0x3618, 0x38010, 0x1c10, 0x11688
.long 0x3878, 0x38020, 0x1c20, 0x11690, 0x3a58, 0x38030, 0x1c30, 0x11698
.long 0x343c, 0x3c000, 0x1c40, 0x11f20, 0x361c, 0x3c010, 0x1c50, 0x11f28
.long 0x387c, 0x3c020, 0x1c60, 0x11f38, 0x3a5c, 0x3c030, 0x1c70, 0x11f40
.long 0x18, 0x1578, 0x1740, 0x1e480, 0x558, 0x1570, 0x18c0, 0x1e4a0
.long 0xa98, 0x1568, 0x1738, 0x1e4c0, 0xfd8, 0x1560, 0x18b8, 0x1e4e0
.long 0x10, 0x1558, 0x1730, 0x1e500, 0x550, 0x1550, 0x18b0, 0x1e520
.long 0xa90, 0x1548, 0x1728, 0x1e540, 0xfd0, 0x1540, 0x18a8, 0x1e560
.long 0x8, 0x1538, 0x1720, 0x1e580, 0x548, 0x1530, 0x18a0, 0x1e5a0
.long 0xa88, 0x1528, 0x1718, 0x1e5c0, 0xfc8, 0x1520, 0x1898, 0x1e5e0
.long 0x0, 0x1518, 0x1710, 0x1e600, 0x540, 0x1510, 0x1890, 0x1e620
.long 0xa80, 0x1508, 0x1708, 0x1e640, 0xfc0, 0x1500, 0x1888, 0x1e660
.long 0x28, 0x1588, 0x1750, 0x1e490, 0x568, 0x1580, 0x18d0, 0x1e4b0
.long 0xaa8, 0x1578, 0x1748, 0x1e4d0, 0xfe8, 0x1570, 0x18c8, 0x1e4f0
.long 0x20, 0x1568, 0x1740, 0x1e510, 0x560, 0x1560, 0x18c0, 0x1e530
.long 0xaa0, 0x1558, 0x1738, 0x1e550, 0xfe0, 0x1550, 0x18b8, 0x1e570
.long 0x18, 0x1548, 0x1730, 0x1e590, 0x558, 0x1540, 0x18b0, 0x1e5b0
.long 0xa98, 0x1538, 0x1728, 0x1e5d0, 0xfd8, 0x1530, 0x18a8, 0x1e5f0
.long 0x10, 0x1528, 0x1720, 0x1e610, 0x550, 0x1520, 0x18a0, 0x1e630
.long 0xa90, 0x1518, 0x1718, 0x1e650, 0xfd0, 0x1510, 0x1898, 0x1e670
.long 0x38, 0x1598, 0x1760, 0x1e4a0, 0x578, 0x1590, 0x18e0, 0x1e4c0
.long 0xab8, 0x1588, 0x1758, 0x1e4e0, 0xff8, 0x1580, 0x18d8, 0x1e500
.long 0x30, 0x1578, 0x1750, 0x1e520, 0x570, 0x1570, 0x18d0, 0x1e540
.long 0xab0, 0x1568, 0x1748, 0x1e560, 0xff0, 0x1560, 0x18c8, 0x1e580
.long 0x28, 0x1558, 0x1740, 0x1e5a0, 0x568, 0x1550, 0x18c0, 0x1e5c0
.long 0xaa8, 0x1548, 0x1738, 0x1e5e0, 0xfe8, 0x1540, 0x18b8, 0x1e600
.long 0x20, 0x1538, 0x1730, 0x1e620, 0x560, 0x1530, 0x18b0, 0x1e640
.long 0xaa0, 0x1528, 0x1728, 0x1e660, 0xfe0, 0x1520, 0x18a8, 0x1e680
.long 0x48, 0x15a8, 0x1770, 0x1e4b0, 0x588, 0x15a0, 0x18f0, 0x1e4d0
.long 0xac8, 0x1598, 0x1768, 0x1e4f0, 0x1008, 0x1590, 0x18e8, 0x1e510
.long 0x40, 0x1588, 0x1760, 0x1e530, 0x580, 0x1580, 0x18e0, 0x1e550
.long 0xac0, 0x1578, 0x1758, 0x1e570, 0x1000, 0x1570, 0x18d8, 0x1e590
.long 0x38, 0x1568, 0x1750, 0x1e5b0, 0x578, 0x1560, 0x18d0, 0x1e5d0
.long 0xab8, 0x1558, 0x1748, 0x1e5f0, 0xff8, 0x1550, 0x18c8, 0x1e610
.long 0x30, 0x1548, 0x1740, 0x1e630, 0x570, 0x1540, 0x18c0, 0x1e650
.long 0xab0, 0x1538, 0x1738, 0x1e670, 0xff0, 0x1530, 0x18b8, 0x1e690
.long 0x800, 0xfa40, 0xfa60, 0x11488, 0x820, 0xfa48, 0xfa68, 0x11490
.long 0x840, 0xfa50, 0xfa70, 0x11498, 0x860, 0xfa58, 0xfa78, 0x114a0
.long 0x888, 0x107b8, 0x107d8, 0x11d28, 0x8a8, 0x107c0, 0x107e0, 0x11d30
.long 0x8c8, 0x107c8, 0x107e8, 0x11d38, 0x8e8, 0x107d0, 0x107f0, 0x11d40
.long 0x910, 0xfa50, 0xfa70, 0x114a8, 0x930, 0xfa58, 0xfa78, 0x114b0
.long 0x950, 0xfa60, 0xfa80, 0x114b8, 0x970, 0xfa68, 0xfa88, 0x114c0
.long 0x998, 0x107c8, 0x107e8, 0x11d48, 0x9b8, 0x107d0, 0x107f0, 0x11d50
.long 0x9d8, 0x107d8, 0x107f8, 0x11d58, 0x9f8, 0x107e0, 0x10800, 0x11d60
.long 0x808, 0xfa80, 0xfaa0, 0x11510, 0x828, 0xfa88, 0xfaa8, 0x11518
.long 0x848, 0xfa90, 0xfab0, 0x11520, 0x868, 0xfa98, 0xfab8, 0x11528
.long 0x890, 0x107f8, 0x10818, 0x11db0, 0x8b0, 0x10800, 0x10820, 0x11db8
.long 0x8d0, 0x10808, 0x10828, 0x11dc0, 0x8f0, 0x10810, 0x10838, 0x11dc8
.long 0x918, 0xfa90, 0xfab0, 0x11530, 0x938, 0xfa98, 0xfab8, 0x11538
.long 0x958, 0xfaa0, 0xfac8, 0x11540, 0x978, 0xfaa8, 0xfad0, 0x11548
.long 0x9a0, 0x10808, 0x10828, 0x11dd0, 0x9c0, 0x10810, 0x10838, 0x11dd8
.long 0x9e0, 0x10818, 0x10840, 0x11de0, 0xa00, 0x10820, 0x10848, 0x11de8
.long 0x810, 0xfac8, 0xfae8, 0x11598, 0x830, 0xfad0, 0xfaf0, 0x115a0
.long 0x850, 0xfad8, 0xfaf8, 0x115a8, 0x870, 0xfae0, 0xfb00, 0x115b0
.long 0x898, 0x10840, 0x10860, 0x11e38, 0x8b8, 0x10848, 0x10868, 0x11e40
.long 0x8d8, 0x10850, 0x10870, 0x11e48, 0x8f8, 0x10858, 0x10878, 0x11e50
.long 0x920, 0xfad8, 0xfaf8, 0x115b8, 0x940, 0xfae0, 0xfb00, 0x115c0
.long 0x960, 0xfae8, 0xfb08, 0x115c8, 0x980, 0xfaf0, 0xfb10, 0x115d0
.long 0x9a8, 0x10850, 0x10870, 0x11e58, 0x9c8, 0x10858, 0x10878, 0x11e60
.long 0x9e8, 0x10860, 0x10880, 0x11e68, 0xa08, 0x10868, 0x10888, 0x11e70
.long 0x818, 0xfb08, 0xfb28, 0x11620, 0x838, 0xfb10, 0xfb30, 0x11628
.long 0x858, 0xfb18, 0xfb38, 0x11630, 0x878, 0xfb20, 0xfb40, 0x11638
.long 0x8a0, 0x10880, 0x108a0, 0x11ec0, 0x8c0, 0x10888, 0x108a8, 0x11ec8
.long 0x8e0, 0x10890, 0x108b0, 0x11ed0, 0x900, 0x10898, 0x108c0, 0x11ed8
.long 0x928, 0xfb18, 0xfb38, 0x11640, 0x948, 0xfb20, 0xfb40, 0x11648
.long 0x968, 0xfb28, 0xfb50, 0x11650, 0x988, 0xfb30, 0xfb58, 0x11658
.long 0x9b0, 0x10890, 0x108b0, 0x11ee0, 0x9d0, 0x10898, 0x108c0, 0x11ee8
.long 0x9f0, 0x108a0, 0x108c8, 0x11ef0, 0xa10, 0x108a8, 0x108d0, 0x11ef8
.long 0x0, 0x0, 0x0, 0x0, 0x0, 0x0, 0x0, 0x0
.long 0x0, 0x0, 0x0, 0x0, 0x0, 0x0, 0x0, 0x0
.long 0x0, 0x0, 0x0, 0x0, 0x0, 0x0, 0x0, 0x0
.long 0x0, 0x0, 0x0, 0x0, 0x0, 0x0, 0x0, 0x0
.long 0x0, 0x0, 0x0, 0x0, 0x0, 0x0, 0x0, 0x0
.long 0x0, 0x0, 0x0, 0x0, 0x0, 0x0, 0x0, 0x0
.long 0x0, 0x0, 0x0, 0x0, 0x0, 0x0, 0x0, 0x0
.long 0x0, 0x0, 0x0, 0x0, 0x0, 0x0, 0x0, 0x0
.long 0x0, 0x0, 0xffffffff, 0x0, 0x0, 0x0, 0xffff0000, 0xffff
.long 0x0, 0x0, 0x0, 0xffffffff, 0x0, 0x0, 0x0, 0xffff0000
.long 0x0, 0x0, 0x0, 0x0, 0x0, 0x0, 0x0, 0x0
.long 0x0, 0x0, 0x0, 0x0, 0x0, 0x0, 0x0, 0x0
.long 0x0, 0x0, 0x0, 0x0, 0x0, 0x0, 0x0, 0x0
.long 0x0, 0x0, 0x0, 0x0, 0x0, 0x0, 0x0, 0x0
.long 0x0, 0x0, 0x0, 0x0, 0x0, 0x0, 0x0, 0x0
.long 0x0, 0x0, 0x0, 0x0, 0x0, 0x0, 0x0, 0x0
.long 0x0, 0x0, 0x0, 0x0, 0x0, 0x0, 0x0, 0x0
.long 0x0, 0x0, 0x0, 0x0, 0xffff, 0x0, 0x0, 0x0
.long 0xffffffff, 0x0, 0x0, 0x0, 0xffff0000, 0xffff, 0x0, 0x0
.long 0x0, 0xffffffff, 0x0, 0x0, 0x0, 0xffff0000, 0xffff, 0x0
.long 0x0, 0x0, 0xffffffff, 0x0, 0x0, 0x0, 0xffff0000, 0xffff
.long 0x0, 0x0, 0x0, 0xffffffff, 0x0, 0x0, 0x0, 0xffff0000
.long 0x0, 0x0, 0x0, 0x0, 0x0, 0x0, 0x0, 0x0
.long 0x0, 0x0, 0x0, 0x0, 0x0, 0x0, 0x0, 0x0
.long 0x0, 0x0, 0x0, 0x0, 0x0, 0x0, 0x0, 0x0
.long 0x0, 0x0, 0x0, 0x0, 0x0, 0x0, 0x0, 0x0
.long 0x0, 0x0, 0x0, 0x0, 0x0, 0x0, 0x0, 0x0
.long 0x0, 0x0, 0x0, 0x0, 0x0, 0x0, 0x0, 0x0
.long 0x0, 0x0, 0x0, 0x0, 0x0, 0x0, 0x0, 0x0
.long 0x0, 0x0, 0x0, 0x0, 0xffff, 0x0, 0x0, 0x0
.long 0xffffffff, 0x0, 0x0, 0x0, 0xffff0000, 0xffff, 0x0, 0x0
.long 0x0, 0xffffffff, 0x0, 0x0, 0x0, 0xffff0000, 0xffff, 0x0
.long 0x0, 0x0, 0x0, 0x3f803f80, 0x0, 0x0, 0x0, 0x3f800000
.long 0x0, 0x0, 0x0, 0x0, 0x0, 0x0, 0x0, 0x0
.long 0x0, 0x0, 0x0, 0x0, 0x0, 0x0, 0x0, 0x0
.long 0x0, 0x0, 0x0, 0x0, 0x0, 0x0, 0x0, 0x0
.long 0x0, 0x0, 0x0, 0x0, 0x0, 0x0, 0x0, 0x0
.long 0x0, 0x0, 0x0, 0x0, 0x0, 0x0, 0x0, 0x0
.long 0x0, 0x0, 0x0, 0x0, 0x0, 0x0, 0x0, 0x0
.long 0x0, 0x0, 0x0, 0x0, 0x0, 0x0, 0x0, 0x0
.long 0x3f803f80, 0x3f80, 0x0, 0x0, 0x3f803f80, 0x3f803f80, 0x0, 0x0
.long 0x3f803f80, 0x3f803f80, 0x3f80, 0x0, 0x3f800000, 0x3f803f80, 0x3f803f80, 0x0
.long 0x0, 0x3f803f80, 0x3f803f80, 0x3f80, 0x0, 0x3f800000, 0x3f803f80, 0x3f803f80
.long 0x0, 0x0, 0x3f803f80, 0x3f803f80, 0x0, 0x0, 0x3f800000, 0x3f803f80
.long 0x0, 0x0, 0x0, 0x3f803f80, 0x0, 0x0, 0x0, 0x3f800000
.long 0x0, 0x0, 0x0, 0x0, 0x0, 0x0, 0x0, 0x0
.long 0x0, 0x0, 0x0, 0x0, 0x0, 0x0, 0x0, 0x0
.long 0x0, 0x0, 0x0, 0x0, 0x0, 0x0, 0x0, 0x0
.long 0x0, 0x0, 0x0, 0x0, 0x0, 0x0, 0x0, 0x0
.long 0x0, 0x0, 0x0, 0x0, 0x0, 0x0, 0x0, 0x0
.long 0x0, 0x0, 0x0, 0x0, 0x0, 0x0, 0x0, 0x0
.long 0x3f80, 0x0, 0x0, 0x0, 0x3f803f80, 0x0, 0x0, 0x0
.long 0x3f803f80, 0x3f80, 0x0, 0x0, 0x3f803f80, 0x3f803f80, 0x0, 0x0
.long 0x3f803f80, 0x3f803f80, 0x3f80, 0x0, 0x3f800000, 0x3f803f80, 0x3f803f80, 0x0
.long 0x0, 0x3f803f80, 0x3f803f80, 0x3f80, 0x0, 0x3f800000, 0x3f803f80, 0x3f803f80
.long 0x0, 0x0, 0x3f803f80, 0x3f803f80, 0x0, 0x0, 0x3f800000, 0x3f803f80
.long 0x0, 0x0, 0x0, 0x0, 0x0, 0x0, 0x0, 0x0
.long 0x0, 0x0, 0x0, 0x0, 0x0, 0x0, 0x0, 0x0
.long 0x0, 0x0, 0x0, 0x0, 0x0, 0x0, 0x0, 0x0
.long 0x0, 0x0, 0x0, 0x0, 0x0, 0x0, 0x0, 0x0
.long 0x0, 0x0, 0x0, 0x0, 0x0, 0x0, 0x0, 0x0
.long 0x0, 0x0, 0x0, 0x0, 0x0, 0x0, 0x0, 0x0
.long 0x0, 0x0, 0x0, 0x0, 0x0, 0x0, 0x0, 0x0
.long 0x3f80, 0x0, 0x0, 0x0, 0x3f803f80, 0x0, 0x0, 0x0
.long 0x0, 0x0, 0x0, 0x0, 0x0, 0x0, 0x0, 0x0
.long 0x0, 0x0, 0x0, 0x0, 0x0, 0x0, 0x0, 0x0
.long 0x0, 0x0, 0x0, 0x0, 0x0, 0x0, 0x0, 0x0
.long 0x0, 0x0, 0x0, 0x0, 0x0, 0x0, 0x0, 0x0
.long 0x0, 0x0, 0x0, 0x0, 0x0, 0x0, 0x0, 0x0
.long 0x0, 0x0, 0x0, 0x0, 0x0, 0x0, 0x0, 0x0
.long 0x0, 0x0, 0x0, 0x0, 0x0, 0x0, 0x0, 0x0
.long 0x0, 0x0, 0x0, 0x0, 0x0, 0x0, 0x0, 0x0
.long 0x0, 0x3f800000, 0x3f803f80, 0x0, 0x0, 0x0, 0x3f803f80, 0x3f80
.long 0x0, 0x0, 0x3f800000, 0x3f803f80, 0x0, 0x0, 0x0, 0x3f803f80
.long 0x0, 0x0, 0x0, 0x3f800000, 0x0, 0x0, 0x0, 0x0
.long 0x0, 0x0, 0x0, 0x0, 0x0, 0x0, 0x0, 0x0
.long 0x0, 0x0, 0x0, 0x0, 0x0, 0x0, 0x0, 0x0
.long 0x0, 0x0, 0x0, 0x0, 0x0, 0x0, 0x0, 0x0
.long 0x0, 0x0, 0x0, 0x0, 0x0, 0x0, 0x0, 0x0
.long 0x0, 0x0, 0x0, 0x0, 0x0, 0x0, 0x0, 0x0
.long 0x0, 0x0, 0x0, 0x0, 0x0, 0x0, 0x0, 0x0
.long 0x0, 0x0, 0x0, 0x0, 0x3f80, 0x0, 0x0, 0x0
.long 0x3f803f80, 0x0, 0x0, 0x0, 0x3f803f80, 0x3f80, 0x0, 0x0
.long 0x3f800000, 0x3f803f80, 0x0, 0x0, 0x0, 0x3f803f80, 0x3f80, 0x0
.long 0x0, 0x3f800000, 0x3f803f80, 0x0, 0x0, 0x0, 0x3f803f80, 0x3f80
.long 0x0, 0x0, 0x3f800000, 0x3f803f80, 0x0, 0x0, 0x0, 0x3f803f80
.long 0x0, 0x0, 0x0, 0x3f800000, 0x0, 0x0, 0x0, 0x0
.long 0x0, 0x0, 0x0, 0x0, 0x0, 0x0, 0x0, 0x0
.long 0x0, 0x0, 0x0, 0x0, 0x0, 0x0, 0x0, 0x0
.long 0x0, 0x0, 0x0, 0x0, 0x0, 0x0, 0x0, 0x0
.long 0x0, 0x0, 0x0, 0x0, 0x0, 0x0, 0x0, 0x0
.long 0x0, 0x0, 0x0, 0x0, 0x0, 0x0, 0x0, 0x0
.long 0x0, 0x0, 0x0, 0x0, 0x0, 0x0, 0x0, 0x0
.long 0x0, 0x0, 0x0, 0x0, 0x3f80, 0x0, 0x0, 0x0
.long 0x3f803f80, 0x0, 0x0, 0x0, 0x3f803f80, 0x3f80, 0x0, 0x0
.long 0x3f800000, 0x3f803f80, 0x0, 0x0, 0x0, 0x3f803f80, 0x3f80, 0x0
.long 0x0, 0x0, 0x3f803f80, 0x3f803f80, 0x0, 0x0, 0x3f800000, 0x3f803f80
.long 0x0, 0x0, 0x0, 0x3f803f80, 0x0, 0x0, 0x0, 0x3f800000
.long 0x0, 0x0, 0x0, 0x0, 0x0, 0x0, 0x0, 0x0
.long 0x0, 0x0, 0x0, 0x0, 0x0, 0x0, 0x0, 0x0
.long 0x0, 0x0, 0x0, 0x0, 0x0, 0x0, 0x0, 0x0
.long 0x0, 0x0, 0x0, 0x0, 0x0, 0x0, 0x0, 0x0
.long 0x0, 0x0, 0x0, 0x0, 0x0, 0x0, 0x0, 0x0
.long 0x0, 0x0, 0x0, 0x0, 0x0, 0x0, 0x0, 0x0
.long 0x3f803f80, 0x3f803f80, 0x3f80, 0x0, 0x3f803f80, 0x3f803f80, 0x3f803f80, 0x0
.long 0x3f803f80, 0x3f803f80, 0x3f803f80, 0x3f80, 0x3f803f80, 0x3f803f80, 0x3f803f80, 0x3f803f80
.long 0x3f803f80, 0x3f803f80, 0x3f803f80, 0x3f803f80, 0x3f800000, 0x3f803f80, 0x3f803f80, 0x3f803f80
.long 0x0, 0x3f803f80, 0x3f803f80, 0x3f803f80, 0x0, 0x3f800000, 0x3f803f80, 0x3f803f80
.long 0x0, 0x0, 0x3f803f80, 0x3f803f80, 0x0, 0x0, 0x3f800000, 0x3f803f80
.long 0x0, 0x0, 0x0, 0x3f803f80, 0x0, 0x0, 0x0, 0x3f800000
.long 0x0, 0x0, 0x0, 0x0, 0x0, 0x0, 0x0, 0x0
.long 0x0, 0x0, 0x0, 0x0, 0x0, 0x0, 0x0, 0x0
.long 0x0, 0x0, 0x0, 0x0, 0x0, 0x0, 0x0, 0x0
.long 0x0, 0x0, 0x0, 0x0, 0x0, 0x0, 0x0, 0x0
.long 0x3f80, 0x0, 0x0, 0x0, 0x3f803f80, 0x0, 0x0, 0x0
.long 0x3f803f80, 0x3f80, 0x0, 0x0, 0x3f803f80, 0x3f803f80, 0x0, 0x0
.long 0x3f803f80, 0x3f803f80, 0x3f80, 0x0, 0x3f803f80, 0x3f803f80, 0x3f803f80, 0x0
.long 0x3f803f80, 0x3f803f80, 0x3f803f80, 0x3f80, 0x3f803f80, 0x3f803f80, 0x3f803f80, 0x3f803f80
.long 0x3f803f80, 0x3f803f80, 0x3f803f80, 0x3f803f80, 0x3f800000, 0x3f803f80, 0x3f803f80, 0x3f803f80
.long 0x0, 0x3f803f80, 0x3f803f80, 0x3f803f80, 0x0, 0x3f800000, 0x3f803f80, 0x3f803f80
.long 0x0, 0x0, 0x0, 0x0, 0x0, 0x0, 0x0, 0x0
.long 0x0, 0x0, 0x0, 0x0, 0x0, 0x0, 0x0, 0x0
.long 0x0, 0x0, 0x0, 0x0, 0x0, 0x0, 0x0, 0x0
.long 0x0, 0x0, 0x0, 0x0, 0x0, 0x0, 0x0, 0x0
.long 0x0, 0x0, 0x0, 0x0, 0x0, 0x0, 0x0, 0x0
.long 0x0, 0x0, 0x0, 0x0, 0x0, 0x0, 0x0, 0x0
.long 0x3f80, 0x0, 0x0, 0x0, 0x3f803f80, 0x0, 0x0, 0x0
.long 0x3f803f80, 0x3f80, 0x0, 0x0, 0x3f803f80, 0x3f803f80, 0x0, 0x0
.long 0x0, 0x0, 0x3f800000, 0x3f803f80, 0x0, 0x0, 0x0, 0x3f803f80
.long 0x0, 0x0, 0x0, 0x3f800000, 0x0, 0x0, 0x0, 0x0
.long 0x0, 0x0, 0x0, 0x0, 0x0, 0x0, 0x0, 0x0
.long 0x0, 0x0, 0x0, 0x0, 0x0, 0x0, 0x0, 0x0
.long 0x0, 0x0, 0x0, 0x0, 0x0, 0x0, 0x0, 0x0
.long 0x0, 0x0, 0x0, 0x0, 0x0, 0x0, 0x0, 0x0
.long 0x0, 0x0, 0x0, 0x0, 0x0, 0x0, 0x0, 0x0
.long 0x0, 0x0, 0x0, 0x0, 0x0, 0x0, 0x0, 0x0
.long 0x3f803f80, 0x3f803f80, 0x0, 0x0, 0x3f803f80, 0x3f803f80, 0x3f80, 0x0
.long 0x3f803f80, 0x3f803f80, 0x3f803f80, 0x0, 0x3f803f80, 0x3f803f80, 0x3f803f80, 0x3f80
.long 0x3f800000, 0x3f803f80, 0x3f803f80, 0x3f803f80, 0x0, 0x3f803f80, 0x3f803f80, 0x3f803f80
.long 0x0, 0x3f800000, 0x3f803f80, 0x3f803f80, 0x0, 0x0, 0x3f803f80, 0x3f803f80
.long 0x0, 0x0, 0x3f800000, 0x3f803f80, 0x0, 0x0, 0x0, 0x3f803f80
.long 0x0, 0x0, 0x0, 0x3f800000, 0x0, 0x0, 0x0, 0x0
.long 0x0, 0x0, 0x0, 0x0, 0x0, 0x0, 0x0, 0x0
.long 0x0, 0x0, 0x0, 0x0, 0x0, 0x0, 0x0, 0x0
.long 0x0, 0x0, 0x0, 0x0, 0x0, 0x0, 0x0, 0x0
.long 0x0, 0x0, 0x0, 0x0, 0x0, 0x0, 0x0, 0x0
.long 0x0, 0x0, 0x0, 0x0, 0x3f80, 0x0, 0x0, 0x0
.long 0x3f803f80, 0x0, 0x0, 0x0, 0x3f803f80, 0x3f80, 0x0, 0x0
.long 0x3f803f80, 0x3f803f80, 0x0, 0x0, 0x3f803f80, 0x3f803f80, 0x3f80, 0x0
.long 0x3f803f80, 0x3f803f80, 0x3f803f80, 0x0, 0x3f803f80, 0x3f803f80, 0x3f803f80, 0x3f80
.long 0x3f800000, 0x3f803f80, 0x3f803f80, 0x3f803f80, 0x0, 0x3f803f80, 0x3f803f80, 0x3f803f80
.long 0x0, 0x3f800000, 0x3f803f80, 0x3f803f80, 0x0, 0x0, 0x3f803f80, 0x3f803f80
.long 0x0, 0x0, 0x0, 0x0, 0x0, 0x0, 0x0, 0x0
.long 0x0, 0x0, 0x0, 0x0, 0x0, 0x0, 0x0, 0x0
.long 0x0, 0x0, 0x0, 0x0, 0x0, 0x0, 0x0, 0x0
.long 0x0, 0x0, 0x0, 0x0, 0x0, 0x0, 0x0, 0x0
.long 0x0, 0x0, 0x0, 0x0, 0x0, 0x0, 0x0, 0x0
.long 0x0, 0x0, 0x0, 0x0, 0x0, 0x0, 0x0, 0x0
.long 0x0, 0x0, 0x0, 0x0, 0x3f80, 0x0, 0x0, 0x0
.long 0x3f803f80, 0x0, 0x0, 0x0, 0x3f803f80, 0x3f80, 0x0, 0x0
.long 0x1e640, 0xfa50, 0xfa58, 0xfa40, 0x1e660, 0xfa70, 0xfa78, 0xfa48
.long 0x1e680, 0xfa90, 0xfa98, 0xfa50, 0x1e6a0, 0xfab0, 0xfab8, 0xfa58
.long 0x1e6c0, 0xfad8, 0xfae0, 0x107b0, 0x1e6e0, 0xfaf8, 0xfb00, 0x107b8
.long 0x1e700, 0xfb18, 0xfb20, 0x107c0, 0x1e720, 0xfb38, 0xfb40, 0x107c8
.long 0x1e740, 0xfb60, 0xfb68, 0x11488, 0x1e760, 0xfb80, 0xfb88, 0x11490
.long 0x1e780, 0xfba0, 0xfba8, 0x11498, 0x1e7a0, 0xfbc0, 0xfbc8, 0x114a0
.long 0x1e7c0, 0xfbe8, 0xfbf0, 0x11488, 0x1e7e0, 0xfc08, 0xfc10, 0x11490
.long 0x1e800, 0xfc28, 0xfc30, 0x11498, 0x1e820, 0xfc48, 0xfc50, 0x114a0
.long 0x1e650, 0xfa58, 0xfa60, 0x136d0, 0x1e670, 0xfa78, 0xfa80, 0x136d8
.long 0x1e690, 0xfa98, 0xfaa0, 0x136e0, 0x1e6b0, 0xfab8, 0xfac8, 0x136e8
.long 0x1e6d0, 0xfae0, 0xfae8, 0x14440, 0x1e6f0, 0xfb00, 0xfb08, 0x14448
.long 0x1e710, 0xfb20, 0xfb28, 0x14450, 0x1e730, 0xfb40, 0xfb50, 0x14458
.long 0x1e750, 0xfb68, 0xfb70, 0x15118, 0x1e770, 0xfb88, 0xfb90, 0x15120
.long 0x1e790, 0xfba8, 0xfbb0, 0x15128, 0x1e7b0, 0xfbc8, 0xfbd8, 0x15130
.long 0x1e7d0, 0xfbf0, 0xfbf8, 0x15118, 0x1e7f0, 0xfc10, 0xfc18, 0x15120
.long 0x1e810, 0xfc30, 0xfc38, 0x15128, 0x1e830, 0xfc50, 0xfc60, 0x15130
.long 0x1e660, 0xfa60, 0xfa68, 0xfa40, 0x1e680, 0xfa80, 0xfa88, 0xfa48
.long 0x1e6a0, 0xfaa0, 0xfaa8, 0xfa50, 0x1e6c0, 0xfac8, 0xfad0, 0xfa58
.long 0x1e6e0, 0xfae8, 0xfaf0, 0x107b0, 0x1e700, 0xfb08, 0xfb10, 0x107b8
.long 0x1e720, 0xfb28, 0xfb30, 0x107c0, 0x1e740, 0xfb50, 0xfb58, 0x107c8
.long 0x1e760, 0xfb70, 0xfb78, 0x11488, 0x1e780, 0xfb90, 0xfb98, 0x11490
.long 0x1e7a0, 0xfbb0, 0xfbb8, 0x11498, 0x1e7c0, 0xfbd8, 0xfbe0, 0x114a0
.long 0x1e7e0, 0xfbf8, 0xfc00, 0x11488, 0x1e800, 0xfc18, 0xfc20, 0x11490
.long 0x1e820, 0xfc38, 0xfc40, 0x11498, 0x1e840, 0xfc60, 0xfc68, 0x114a0
.long 0x1e670, 0xfa68, 0xfa70, 0x136d0, 0x1e690, 0xfa88, 0xfa90, 0x136d8
.long 0x1e6b0, 0xfaa8, 0xfab0, 0x136e0, 0x1e6d0, 0xfad0, 0xfad8, 0x136e8
.long 0x1e6f0, 0xfaf0, 0xfaf8, 0x14440, 0x1e710, 0xfb10, 0xfb18, 0x14448
.long 0x1e730, 0xfb30, 0xfb38, 0x14450, 0x1e750, 0xfb58, 0xfb60, 0x14458
.long 0x1e770, 0xfb78, 0xfb80, 0x15118, 0x1e790, 0xfb98, 0xfba0, 0x15120
.long 0x1e7b0, 0xfbb8, 0xfbc0, 0x15128, 0x1e7d0, 0xfbe0, 0xfbe8, 0x15130
.long 0x1e7f0, 0xfc00, 0xfc08, 0x15118, 0x1e810, 0xfc20, 0xfc28, 0x15120
.long 0x1e830, 0xfc40, 0xfc48, 0x15128, 0x1e850, 0xfc68, 0xfc70, 0x15130
.long 0x800, 0x8000, 0x3400, 0x3400, 0xa80, 0x8008, 0x3410, 0x3510
.long 0x808, 0x8010, 0x3420, 0x3620, 0xa88, 0x8018, 0x3430, 0x3730
.long 0x810, 0x8080, 0x3440, 0x3840, 0xa90, 0x8088, 0x3450, 0x3950
.long 0x818, 0x8090, 0x3460, 0x3a60, 0xa98, 0x8098, 0x3470, 0x3b70
.long 0x820, 0x8100, 0x3480, 0x3404, 0xaa0, 0x8108, 0x3490, 0x3514
.long 0x828, 0x8110, 0x34a0, 0x3624, 0xaa8, 0x8118, 0x34b0, 0x3734
.long 0x830, 0x8180, 0x34c0, 0x3844, 0xab0, 0x8188, 0x34d0, 0x3954
.long 0x838, 0x8190, 0x34e0, 0x3a64, 0xab8, 0x8198, 0x34f0, 0x3b74
.long 0x840, 0x8200, 0x3510, 0x3408, 0xac0, 0x8208, 0x3520, 0x3518
.long 0x848, 0x8210, 0x3530, 0x3628, 0xac8, 0x8218, 0x3540, 0x3738
.long 0x850, 0x8280, 0x3550, 0x3848, 0xad0, 0x8288, 0x3560, 0x3958
.long 0x858, 0x8290, 0x3570, 0x3a68, 0xad8, 0x8298, 0x3580, 0x3b78
.long 0x860, 0x8300, 0x3590, 0x340c, 0xae0, 0x8308, 0x35a0, 0x351c
.long 0x868, 0x8310, 0x35b0, 0x362c, 0xae8, 0x8318, 0x35c0, 0x373c
.long 0x870, 0x8380, 0x35d0, 0x384c, 0xaf0, 0x8388, 0x35e0, 0x395c
.long 0x878, 0x8390, 0x35f0, 0x3a6c, 0xaf8, 0x8398, 0x3600, 0x3b7c
.long 0x888, 0x8400, 0x3620, 0x3410, 0xb08, 0x8408, 0x3630, 0x3520
.long 0x890, 0x8410, 0x3640, 0x3630, 0xb10, 0x8418, 0x3650, 0x3740
.long 0x898, 0x8480, 0x3660, 0x3850, 0xb18, 0x8488, 0x3670, 0x3960
.long 0x8a0, 0x8490, 0x3680, 0x3a70, 0xb20, 0x8498, 0x3690, 0x3b80
.long 0x8a8, 0x8500, 0x36a0, 0x3414, 0xb28, 0x8508, 0x36b0, 0x3524
.long 0x8b0, 0x8510, 0x36c0, 0x3634, 0xb30, 0x8518, 0x36d0, 0x3744
.long 0x8b8, 0x8580, 0x36e0, 0x3854, 0xb38, 0x8588, 0x36f0, 0x3964
.long 0x8c0, 0x8590, 0x3700, 0x3a74, 0xb40, 0x8598, 0x3710, 0x3b84
.long 0x8c8, 0x8600, 0x3730, 0x3418, 0xb48, 0x8608, 0x3740, 0x3528
.long 0x8d0, 0x8610, 0x3750, 0x3638, 0xb50, 0x8618, 0x3760, 0x3748
.long 0x8d8, 0x8680, 0x3770, 0x3858, 0xb58, 0x8688, 0x3780, 0x3968
.long 0x8e0, 0x8690, 0x3790, 0x3a78, 0xb60, 0x8698, 0x37a0, 0x3b88
.long 0x8e8, 0x8700, 0x37b0, 0x341c, 0xb68, 0x8708, 0x37c0, 0x352c
.long 0x8f0, 0x8710, 0x37d0, 0x363c, 0xb70, 0x8718, 0x37e0, 0x374c
.long 0x8f8, 0x8780, 0x37f0, 0x385c, 0xb78, 0x8788, 0x3800, 0x396c
.long 0x900, 0x8790, 0x3810, 0x3a7c, 0xb80, 0x8798, 0x3820, 0x3b8c
L_fin:
.section .rodata,"a"
.p2align 6
.amdhsa_kernel gated_mix__ssm_conv_s4d__ssm_conv_s4d__prompt_kernel
  .amdhsa_next_free_vgpr 256
  .amdhsa_next_free_sgpr 102
  .amdhsa_accum_offset 256
  .amdhsa_group_segment_fixed_size 0
  .amdhsa_kernarg_size 144
  .amdhsa_user_sgpr_count 2
  .amdhsa_user_sgpr_kernarg_segment_ptr 1
  .amdhsa_system_sgpr_workgroup_id_x 1
.end_amdhsa_kernel
```
